```python
import torch

def _softmax(x, axis=-1):
    return torch.softmax(x, dim=axis)
def _gelu(x):
    return torch.nn.functional.gelu(x, approximate="tanh")
def _silu(x):
    return torch.nn.functional.silu(x)
def _sigmoid(x):
    return torch.sigmoid(x)
def _layernorm(x, axis=-1, eps=1e-5):
    m = x.mean(dim=axis, keepdim=True)
    v = x.var(dim=axis, keepdim=True, unbiased=False)
    return (x - m) / torch.sqrt(v + eps)
def _scatter_add(tgt, idx, src, axis=0):
    return tgt.clone().index_add_(axis, idx, src)
def _segment_sum(src, seg, n):
    out = torch.zeros((n,) + src.shape[1:], dtype=src.dtype)
    return out.index_add_(0, seg, src)
def _pad(x, pw):
    flat = tuple(v for pair in reversed(pw) for v in pair)
    return torch.nn.functional.pad(x, flat)

kernel_name = 'parallel_sum__sliding_block_cached__dense_activation_gelu__decode'

def setup_inputs():

    _w = (lambda a: (lambda t: t.to(torch.bfloat16) if t.is_floating_point() else t)(torch.as_tensor(a)))
    def _A_setup():
        B, Sq, D = 1, 1, 448
        Hq, Hkv, Sk, Dh = 16, 8, 65536, 256
        assert Hq % Hkv == 0, (Hq, Hkv)
        return {
            "x": _w((lambda *s: torch.randn(*s, dtype=torch.bfloat16) * 0.05)(B, Sq, D)),
            "k_cache": _w((lambda *s: torch.randn(*s, dtype=torch.bfloat16) * 3.2)(B, Hkv, Sk, Dh)),
            "v_cache": _w((lambda *s: torch.randn(*s, dtype=torch.bfloat16) * 0.8)(B, Hkv, Sk, Dh)),
            "wq": _w((lambda *s: torch.randn(*s, dtype=torch.bfloat16) * 3.2)(D, Hq * Dh) * (D ** -0.5)),
            "wo": _w((lambda *s: torch.randn(*s, dtype=torch.bfloat16) * 0.8)(Hq * Dh, D) * ((Hq * Dh) ** -0.5)),
        }
    _A_in = _A_setup()

    def _B_setup():
        B, S, D, F = 1, 1, 448, 1792
        return {
            "x": _w((lambda *s: torch.randn(*s, dtype=torch.bfloat16) * 0.05)(B, S, D)),
            "w1": _w((lambda *s: torch.randn(*s, dtype=torch.bfloat16) * 3.2)(D, F) * (D ** -0.5)),
            "b1": _w((lambda *s: torch.randn(*s, dtype=torch.bfloat16) * 3.2)(F) * 0.01),
            "w2": _w((lambda *s: torch.randn(*s, dtype=torch.bfloat16) * 0.2)(F, D) * (F ** -0.5)),
            "b2": _w((lambda *s: torch.randn(*s, dtype=torch.bfloat16) * 0.2)(D) * 0.01),
        }
    _B_in = _B_setup()

    return {
        "A_x": _A_in["x"],
        "A_k_cache": _A_in["k_cache"],
        "A_v_cache": _A_in["v_cache"],
        "A_wq": _A_in["wq"],
        "A_wo": _A_in["wo"],
        "B_x": _B_in["x"],
        "B_w1": _B_in["w1"],
        "B_b1": _B_in["b1"],
        "B_w2": _B_in["w2"],
        "B_b2": _B_in["b2"],
    }

def reference(A_x, A_k_cache, A_v_cache, A_wq, A_wo, B_x, B_w1, B_b1, B_w2, B_b2):
    def _A_ref(x, k_cache, v_cache, wq, wo):
        B, Sq, D = x.shape
        Hq, Dh = 16, 256
        Hkv, Sk = k_cache.shape[1], k_cache.shape[2]
        W = min(4096, max(256, Sk // 4))
        rep = Hq // Hkv
        q = (lambda x, *d: x.permute(*d))((x @ wq).reshape(B, Sq, Hq, Dh), 0, 2, 1, 3)
        k = (lambda x, n, axis: torch.repeat_interleave(x, n, dim=axis))(k_cache[:, :, Sk - W:, :], rep, axis=1)
        v = (lambda x, n, axis: torch.repeat_interleave(x, n, dim=axis))(v_cache[:, :, Sk - W:, :], rep, axis=1)
        scores = torch.einsum("bhqd,bhkd->bhqk", q, k) * (Dh ** -0.5)
        p = _softmax(scores, axis=-1)
        o = torch.einsum("bhqk,bhkd->bhqd", p, v)
        return (lambda x, *d: x.permute(*d))(o, 0, 2, 1, 3).reshape(B, Sq, Hq * Dh) @ wo

    def _B_ref(x, w1, b1, w2, b2):
        h = torch.einsum("bsd,df->bsf", x, w1) + b1
        h = _gelu(h)
        return torch.einsum("bsf,fd->bsd", h, w2) + b2

    x = A_x
    xn = _layernorm(x, axis=-1)
    return x + _A_ref(xn, A_k_cache, A_v_cache, A_wq, A_wo) + _B_ref(xn, B_w1, B_b1, B_w2, B_b2)
```

```asm
; @launch grid=(256,1,1) block=(704,1,1) lds=8192
.amdgcn_target "amdgcn-amd-amdhsa--gfx950"
.text
.globl parallel_sum__sliding_block_cached__dense_activation_gelu__decode_kernel
.p2align 8
.type parallel_sum__sliding_block_cached__dense_activation_gelu__decode_kernel,@function
parallel_sum__sliding_block_cached__dense_activation_gelu__decode_kernel:
s_getpc_b64 s[86:87]
s_cmp_ge_u32 s2, 256
s_cbranch_scc1 L_end
v_lshrrev_b32 v1, 6, v0
v_and_b32 v0, 63, v0
v_readfirstlane_b32 s3, v1
s_cmp_lg_u32 s3, 10
s_cbranch_scc1 L_noinit
s_lshr_b32 s8, s2, 3
s_and_b32 s8, s8, 15
s_lshl_b32 s8, s8, 10
s_min_u32 s8, s8, 12940
v_lshlrev_b32 v2, 4, v0
v_add_u32 v2, s8, v2
global_load_dwordx4 v[16:19], v2, s[86:87]
v_lshlrev_b32 v2, 2, v0
v_mov_b32 v3, 0
ds_write_b32 v2, v3
s_waitcnt lgkmcnt(0)
L_noinit:
s_load_dwordx16 s[16:31], s[0:1], 0
s_load_dwordx8 s[32:39], s[0:1], 64
s_load_dwordx2 s[40:41], s[0:1], 96
s_barrier
s_and_b32 s4, s2, 7
s_lshr_b32 s5, s2, 3
s_mov_b32 s13, 0x05040100
s_mov_b32 s14, 0x07060302
s_cmp_lg_u32 s3, 0
s_cbranch_scc1 L_others
L_roleQ:
s_setprio 3
v_mov_b32 v3, 0
v_lshlrev_b32 v4, 4, v0
v_lshrrev_b32 v5, 3, v0
v_min_u32 v6, 5, v5
v_and_b32 v7, 7, v0
v_lshlrev_b32 v7, 4, v7
v_lshl_add_u32 v5, v5, 16, v7
v_lshl_add_u32 v6, v6, 16, v7
s_lshr_b32 s84, s5, 3
s_mul_i32 s82, s84, 917504
s_lshl_b32 s9, s4, 10
s_add_u32 s82, s82, s9
s_and_b32 s9, s5, 7
s_lshl_b32 s9, s9, 7
s_add_u32 s82, s82, s9
s_waitcnt lgkmcnt(0)
s_mov_b32 s44, s16
s_and_b32 s45, s17, 0xffff
s_mov_b32 s46, 896
s_mov_b32 s47, 0x20000
s_mov_b32 s48, s22
s_and_b32 s49, s23, 0xffff
s_mov_b32 s50, 3670016
s_mov_b32 s51, 0x20000
buffer_load_dwordx4 v[8:11], v4, s[44:47], 0 offen
s_add_u32 s9, s82, 0
buffer_load_dwordx4 v[24:27], v5, s[48:51], s9 offen nt
s_add_u32 s9, s82, 8192
buffer_load_dwordx4 v[28:31], v5, s[48:51], s9 offen nt
s_add_u32 s9, s82, 16384
buffer_load_dwordx4 v[32:35], v5, s[48:51], s9 offen nt
s_add_u32 s9, s82, 24576
buffer_load_dwordx4 v[36:39], v5, s[48:51], s9 offen nt
s_add_u32 s9, s82, 32768
buffer_load_dwordx4 v[40:43], v5, s[48:51], s9 offen nt
s_add_u32 s9, s82, 40960
buffer_load_dwordx4 v[44:47], v5, s[48:51], s9 offen nt
s_add_u32 s9, s82, 49152
buffer_load_dwordx4 v[48:51], v5, s[48:51], s9 offen nt
s_add_u32 s9, s82, 57344
buffer_load_dwordx4 v[52:55], v5, s[48:51], s9 offen nt
s_add_u32 s9, s82, 524288
buffer_load_dwordx4 v[56:59], v6, s[48:51], s9 offen nt
s_add_u32 s9, s82, 532480
buffer_load_dwordx4 v[60:63], v6, s[48:51], s9 offen nt
s_add_u32 s9, s82, 540672
buffer_load_dwordx4 v[64:67], v6, s[48:51], s9 offen nt
s_add_u32 s9, s82, 548864
buffer_load_dwordx4 v[68:71], v6, s[48:51], s9 offen nt
s_add_u32 s9, s82, 557056
buffer_load_dwordx4 v[72:75], v6, s[48:51], s9 offen nt
s_add_u32 s9, s82, 565248
buffer_load_dwordx4 v[76:79], v6, s[48:51], s9 offen nt
s_add_u32 s9, s82, 573440
buffer_load_dwordx4 v[80:83], v6, s[48:51], s9 offen nt
s_add_u32 s9, s82, 581632
buffer_load_dwordx4 v[84:87], v6, s[48:51], s9 offen nt
v_mov_b32 v2, 1
s_mov_b64 exec, 1
ds_add_u32 v3, v2 offset:56
s_mov_b64 exec, -1
s_load_dword s7, s[40:41], 0
s_mov_b32 s52, s40
s_and_b32 s53, s41, 0xffff
s_mov_b32 s54, 134217728
s_mov_b32 s55, 0x20000
s_getreg_b32 s80, hwreg(HW_REG_XCC_ID, 0, 3)
s_waitcnt vmcnt(16)
v_lshlrev_b32 v12, 16, v8
v_and_b32 v13, 0xffff0000, v8
v_lshlrev_b32 v14, 16, v9
v_and_b32 v15, 0xffff0000, v9
v_lshlrev_b32 v16, 16, v10
v_and_b32 v17, 0xffff0000, v10
v_lshlrev_b32 v18, 16, v11
v_and_b32 v19, 0xffff0000, v11
v_add_f32 v2, v12, v13
v_add_f32 v2, v2, v14
v_add_f32 v2, v2, v15
v_add_f32 v2, v2, v16
v_add_f32 v2, v2, v17
v_add_f32 v2, v2, v18
v_add_f32 v2, v2, v19
s_nop 1
v_add_f32_dpp v2, v2, v2 row_ror:8 row_mask:0xf bank_mask:0xf
s_nop 1
v_add_f32_dpp v2, v2, v2 row_ror:4 row_mask:0xf bank_mask:0xf
s_nop 1
v_add_f32_dpp v2, v2, v2 row_ror:2 row_mask:0xf bank_mask:0xf
s_nop 1
v_add_f32_dpp v2, v2, v2 row_ror:1 row_mask:0xf bank_mask:0xf
v_mov_b32 v3, v2
s_nop 1
v_permlane16_swap_b32 v2, v3
s_nop 1
v_add_f32 v2, v2, v3
v_mov_b32 v3, v2
s_nop 1
v_permlane32_swap_b32 v2, v3
s_nop 1
v_add_f32 v2, v2, v3
v_mul_f32 v2, 0x3b124925, v2
v_sub_f32 v6, v12, v2
v_mul_f32 v7, v6, v6
v_sub_f32 v6, v13, v2
v_fmac_f32 v7, v6, v6
v_sub_f32 v6, v14, v2
v_fmac_f32 v7, v6, v6
v_sub_f32 v6, v15, v2
v_fmac_f32 v7, v6, v6
v_sub_f32 v6, v16, v2
v_fmac_f32 v7, v6, v6
v_sub_f32 v6, v17, v2
v_fmac_f32 v7, v6, v6
v_sub_f32 v6, v18, v2
v_fmac_f32 v7, v6, v6
v_sub_f32 v6, v19, v2
v_fmac_f32 v7, v6, v6
v_cmp_gt_u32 vcc, 56, v0
s_nop 1
v_cndmask_b32 v7, 0, v7, vcc
s_nop 1
v_add_f32_dpp v7, v7, v7 row_ror:8 row_mask:0xf bank_mask:0xf
s_nop 1
v_add_f32_dpp v7, v7, v7 row_ror:4 row_mask:0xf bank_mask:0xf
s_nop 1
v_add_f32_dpp v7, v7, v7 row_ror:2 row_mask:0xf bank_mask:0xf
s_nop 1
v_add_f32_dpp v7, v7, v7 row_ror:1 row_mask:0xf bank_mask:0xf
v_mov_b32 v3, v7
s_nop 1
v_permlane16_swap_b32 v7, v3
s_nop 1
v_add_f32 v7, v7, v3
v_mov_b32 v3, v7
s_nop 1
v_permlane32_swap_b32 v7, v3
s_nop 1
v_add_f32 v7, v7, v3
v_mul_f32 v7, 0x3b124925, v7
v_cvt_pk_bf16_f32 v2, v2, v2
v_lshlrev_b32 v2, 16, v2
v_cvt_pk_bf16_f32 v7, v7, v7
v_lshlrev_b32 v7, 16, v7
v_add_f32 v7, 0x3727c5ac, v7
v_cvt_pk_bf16_f32 v7, v7, v7
v_lshlrev_b32 v7, 16, v7
v_sqrt_f32 v7, v7
s_nop 0
v_cvt_pk_bf16_f32 v7, v7, v7
v_lshlrev_b32 v7, 16, v7
v_rcp_f32 v7, v7
v_sub_f32 v12, v12, v2
v_sub_f32 v13, v13, v2
v_cvt_pk_bf16_f32 v6, v12, v13
v_lshlrev_b32 v12, 16, v6
v_and_b32 v13, 0xffff0000, v6
v_mul_f32 v12, v12, v7
v_mul_f32 v13, v13, v7
v_cvt_pk_bf16_f32 v8, v12, v13
v_cndmask_b32 v8, 0, v8, vcc
v_sub_f32 v14, v14, v2
v_sub_f32 v15, v15, v2
v_cvt_pk_bf16_f32 v6, v14, v15
v_lshlrev_b32 v14, 16, v6
v_and_b32 v15, 0xffff0000, v6
v_mul_f32 v14, v14, v7
v_mul_f32 v15, v15, v7
v_cvt_pk_bf16_f32 v9, v14, v15
v_cndmask_b32 v9, 0, v9, vcc
v_sub_f32 v16, v16, v2
v_sub_f32 v17, v17, v2
v_cvt_pk_bf16_f32 v6, v16, v17
v_lshlrev_b32 v16, 16, v6
v_and_b32 v17, 0xffff0000, v6
v_mul_f32 v16, v16, v7
v_mul_f32 v17, v17, v7
v_cvt_pk_bf16_f32 v10, v16, v17
v_cndmask_b32 v10, 0, v10, vcc
v_sub_f32 v18, v18, v2
v_sub_f32 v19, v19, v2
v_cvt_pk_bf16_f32 v6, v18, v19
v_lshlrev_b32 v18, 16, v6
v_and_b32 v19, 0xffff0000, v6
v_mul_f32 v18, v18, v7
v_mul_f32 v19, v19, v7
v_cvt_pk_bf16_f32 v11, v18, v19
v_cndmask_b32 v11, 0, v11, vcc
s_waitcnt lgkmcnt(0)
s_add_u32 s7, s7, 8
s_andn2_b32 s7, s7, 7
v_mov_b32 v3, 0
v_mov_b32 v6, s7
s_mov_b64 exec, 1
ds_write_b32 v3, v6 offset:72
s_mov_b64 exec, -1
ds_write_b128 v4, v[8:11] offset:256
v_mov_b32 v6, 1
s_mov_b64 exec, 1
ds_add_u32 v3, v6 offset:16
s_mov_b64 exec, -1
v_bfe_u32 v2, v0, 1, 1
v_lshrrev_b32 v7, 4, v0
v_lshl_add_u32 v2, v7, 1, v2
v_lshlrev_b32 v2, 4, v2
s_mul_i32 s8, s84, 224
v_add_u32 v2, s8, v2
ds_read_b128 v[152:155], v2 offset:256
ds_read_b128 v[156:159], v2 offset:384
v_cmp_gt_u32 vcc, 48, v0
s_nop 0
s_waitcnt lgkmcnt(0)
v_cndmask_b32 v156, 0, v156, vcc
v_cndmask_b32 v157, 0, v157, vcc
v_cndmask_b32 v158, 0, v158, vcc
v_cndmask_b32 v159, 0, v159, vcc
s_waitcnt vmcnt(8)
v_mov_b32 v6, 1
s_mov_b64 exec, 1
ds_add_u32 v3, v6 offset:48
s_mov_b64 exec, -1
v_perm_b32 v88, v28, v24, s13
v_perm_b32 v92, v28, v24, s14
v_perm_b32 v96, v29, v25, s13
v_perm_b32 v100, v29, v25, s14
v_perm_b32 v104, v30, v26, s13
v_perm_b32 v108, v30, v26, s14
v_perm_b32 v112, v31, v27, s13
v_perm_b32 v116, v31, v27, s14
v_perm_b32 v89, v36, v32, s13
v_perm_b32 v93, v36, v32, s14
v_perm_b32 v97, v37, v33, s13
v_perm_b32 v101, v37, v33, s14
v_perm_b32 v105, v38, v34, s13
v_perm_b32 v109, v38, v34, s14
v_perm_b32 v113, v39, v35, s13
v_perm_b32 v117, v39, v35, s14
v_perm_b32 v90, v44, v40, s13
v_perm_b32 v94, v44, v40, s14
v_perm_b32 v98, v45, v41, s13
v_perm_b32 v102, v45, v41, s14
v_perm_b32 v106, v46, v42, s13
v_perm_b32 v110, v46, v42, s14
v_perm_b32 v114, v47, v43, s13
v_perm_b32 v118, v47, v43, s14
v_perm_b32 v91, v52, v48, s13
v_perm_b32 v95, v52, v48, s14
v_perm_b32 v99, v53, v49, s13
v_perm_b32 v103, v53, v49, s14
v_perm_b32 v107, v54, v50, s13
v_perm_b32 v111, v54, v50, s14
v_perm_b32 v115, v55, v51, s13
v_perm_b32 v119, v55, v51, s14
s_nop 1
v_mfma_f32_16x16x32_bf16 v[120:123], v[152:155], v[88:91], 0
v_mfma_f32_16x16x32_bf16 v[124:127], v[152:155], v[92:95], 0
v_mfma_f32_16x16x32_bf16 v[128:131], v[152:155], v[96:99], 0
v_mfma_f32_16x16x32_bf16 v[132:135], v[152:155], v[100:103], 0
v_mfma_f32_16x16x32_bf16 v[136:139], v[152:155], v[104:107], 0
v_mfma_f32_16x16x32_bf16 v[140:143], v[152:155], v[108:111], 0
v_mfma_f32_16x16x32_bf16 v[144:147], v[152:155], v[112:115], 0
v_mfma_f32_16x16x32_bf16 v[148:151], v[152:155], v[116:119], 0
s_waitcnt vmcnt(6)
v_perm_b32 v88, v60, v56, s13
v_perm_b32 v92, v60, v56, s14
v_perm_b32 v96, v61, v57, s13
v_perm_b32 v100, v61, v57, s14
v_perm_b32 v104, v62, v58, s13
v_perm_b32 v108, v62, v58, s14
v_perm_b32 v112, v63, v59, s13
v_perm_b32 v116, v63, v59, s14
s_waitcnt vmcnt(4)
v_perm_b32 v89, v68, v64, s13
v_perm_b32 v93, v68, v64, s14
v_perm_b32 v97, v69, v65, s13
v_perm_b32 v101, v69, v65, s14
v_perm_b32 v105, v70, v66, s13
v_perm_b32 v109, v70, v66, s14
v_perm_b32 v113, v71, v67, s13
v_perm_b32 v117, v71, v67, s14
s_waitcnt vmcnt(2)
v_perm_b32 v90, v76, v72, s13
v_perm_b32 v94, v76, v72, s14
v_perm_b32 v98, v77, v73, s13
v_perm_b32 v102, v77, v73, s14
v_perm_b32 v106, v78, v74, s13
v_perm_b32 v110, v78, v74, s14
v_perm_b32 v114, v79, v75, s13
v_perm_b32 v118, v79, v75, s14
s_waitcnt vmcnt(0)
v_perm_b32 v91, v84, v80, s13
v_perm_b32 v95, v84, v80, s14
v_perm_b32 v99, v85, v81, s13
v_perm_b32 v103, v85, v81, s14
v_perm_b32 v107, v86, v82, s13
v_perm_b32 v111, v86, v82, s14
v_perm_b32 v115, v87, v83, s13
v_perm_b32 v119, v87, v83, s14
s_nop 1
v_mfma_f32_16x16x32_bf16 v[120:123], v[156:159], v[88:91], v[120:123]
v_mfma_f32_16x16x32_bf16 v[124:127], v[156:159], v[92:95], v[124:127]
v_mfma_f32_16x16x32_bf16 v[128:131], v[156:159], v[96:99], v[128:131]
v_mfma_f32_16x16x32_bf16 v[132:135], v[156:159], v[100:103], v[132:135]
v_mfma_f32_16x16x32_bf16 v[136:139], v[156:159], v[104:107], v[136:139]
v_mfma_f32_16x16x32_bf16 v[140:143], v[156:159], v[108:111], v[140:143]
v_mfma_f32_16x16x32_bf16 v[144:147], v[156:159], v[112:115], v[144:147]
v_mfma_f32_16x16x32_bf16 v[148:151], v[156:159], v[116:119], v[148:151]
s_or_b32 s81, s7, s80
v_mov_b32 v9, s81
s_mul_i32 s8, s4, 12288
s_add_u32 s83, s8, 20480
s_mul_i32 s9, s5, 384
s_add_u32 s82, s83, s9
s_nop 3
v_add_f32_dpp v12, v122, v120 row_shl:8 row_mask:0xf bank_mask:0xf
v_add_f32_dpp v13, v126, v124 row_shl:8 row_mask:0xf bank_mask:0xf
v_add_f32_dpp v14, v130, v128 row_shl:8 row_mask:0xf bank_mask:0xf
v_add_f32_dpp v16, v134, v132 row_shl:8 row_mask:0xf bank_mask:0xf
v_add_f32_dpp v17, v138, v136 row_shl:8 row_mask:0xf bank_mask:0xf
v_add_f32_dpp v18, v142, v140 row_shl:8 row_mask:0xf bank_mask:0xf
v_add_f32_dpp v20, v146, v144 row_shl:8 row_mask:0xf bank_mask:0xf
s_nop 3
v_add_f32_dpp v21, v150, v148 row_shl:8 row_mask:0xf bank_mask:0xf
v_mov_b32 v15, v9
v_mov_b32 v19, v9
v_mov_b32 v22, v9
v_mov_b32 v23, v9
s_mov_b64 exec, 0xff
buffer_store_dwordx4 v[12:15], v4, s[52:55], s82 offen offset:0
buffer_store_dwordx4 v[16:19], v4, s[52:55], s82 offen offset:128
buffer_store_dwordx4 v[20:23], v4, s[52:55], s82 offen offset:256
s_mov_b64 exec, -1
v_lshrrev_b32 v2, 3, v0
v_mul_u32_u24 v2, 384, v2
v_and_b32 v7, 7, v0
v_lshl_add_u32 v2, v7, 4, v2
v_mov_b32 v10, s7
v_mov_b32 v11, s81
s_mov_b32 s85, 0
s_mov_b32 s80, 0
s_mov_b32 s12, 0
L_lw_1:
ds_read_b32 v7, v3 offset:32
s_waitcnt lgkmcnt(0)
v_readfirstlane_b32 s8, v7
s_cmp_ge_u32 s8, 4
s_cbranch_scc1 L_lwd_2
s_sleep 1
s_add_u32 s12, s12, 1
s_cmp_lt_u32 s12, 2400000
s_cbranch_scc1 L_lw_1
L_lwd_2:
L_qpoll:
s_cmp_ge_u32 s85, 4
s_cselect_b32 s10, s85, 0
s_and_b32 s10, s10, 1
s_mul_i32 s10, s10, 262144
s_add_u32 s8, s10, s83
s_add_u32 s9, s8, 0
buffer_load_dwordx4 v[24:27], v2, s[52:55], s9 offen offset:0 sc1
buffer_load_dwordx4 v[28:31], v2, s[52:55], s9 offen offset:128 sc1
buffer_load_dwordx4 v[32:35], v2, s[52:55], s9 offen offset:256 sc1
s_add_u32 s9, s8, 3072
buffer_load_dwordx4 v[36:39], v2, s[52:55], s9 offen offset:0 sc1
buffer_load_dwordx4 v[40:43], v2, s[52:55], s9 offen offset:128 sc1
buffer_load_dwordx4 v[44:47], v2, s[52:55], s9 offen offset:256 sc1
s_add_u32 s9, s8, 6144
buffer_load_dwordx4 v[48:51], v2, s[52:55], s9 offen offset:0 sc1
buffer_load_dwordx4 v[52:55], v2, s[52:55], s9 offen offset:128 sc1
buffer_load_dwordx4 v[56:59], v2, s[52:55], s9 offen offset:256 sc1
s_add_u32 s9, s8, 9216
buffer_load_dwordx4 v[60:63], v2, s[52:55], s9 offen offset:0 sc1
buffer_load_dwordx4 v[64:67], v2, s[52:55], s9 offen offset:128 sc1
buffer_load_dwordx4 v[68:71], v2, s[52:55], s9 offen offset:256 sc1
s_cmp_lg_u32 s85, 0
s_cbranch_scc1 L_q_nosig
v_mov_b32 v6, 1
s_mov_b64 exec, 1
ds_add_u32 v3, v6 offset:36
s_mov_b64 exec, -1
L_q_nosig:
s_waitcnt vmcnt(0)
v_xor_b32 v6, v27, v10
v_xor_b32 v7, v31, v10
v_or_b32 v6, v6, v7
v_xor_b32 v7, v35, v10
v_or_b32 v6, v6, v7
v_xor_b32 v7, v39, v10
v_or_b32 v6, v6, v7
v_xor_b32 v7, v43, v10
v_or_b32 v6, v6, v7
v_xor_b32 v7, v47, v10
v_or_b32 v6, v6, v7
v_xor_b32 v7, v51, v10
v_or_b32 v6, v6, v7
v_xor_b32 v7, v55, v10
v_or_b32 v6, v6, v7
v_xor_b32 v7, v59, v10
v_or_b32 v6, v6, v7
v_xor_b32 v7, v63, v10
v_or_b32 v6, v6, v7
v_xor_b32 v7, v67, v10
v_or_b32 v6, v6, v7
v_xor_b32 v7, v71, v10
v_or_b32 v6, v6, v7
v_cmp_lt_u32 vcc, 7, v6
s_cmp_eq_u64 vcc, 0
s_cbranch_scc1 L_qgot
s_add_u32 s85, s85, 1
s_cmp_lg_u32 s85, 4
s_cbranch_scc1 L_q_nob
s_mov_b64 exec, 0xff
s_add_u32 s11, s82, 262144
buffer_store_dwordx4 v[12:15], v4, s[52:55], s11 offen offset:0 sc1
buffer_store_dwordx4 v[16:19], v4, s[52:55], s11 offen offset:128 sc1
buffer_store_dwordx4 v[20:23], v4, s[52:55], s11 offen offset:256 sc1
s_mov_b64 exec, -1
s_mov_b32 s80, 1
L_q_nob:
s_cmp_lt_u32 s85, 600000
s_cbranch_scc1 L_qpoll
L_qgot:
v_xor_b32 v5, v27, v11
v_xor_b32 v6, v39, v11
v_or_b32 v5, v5, v6
v_xor_b32 v6, v51, v11
v_or_b32 v5, v5, v6
v_xor_b32 v6, v63, v11
v_or_b32 v5, v5, v6
v_add_f32 v24, v24, v36
v_add_f32 v48, v48, v60
v_add_f32 v25, v25, v37
v_add_f32 v49, v49, v61
v_add_f32 v26, v26, v38
v_add_f32 v50, v50, v62
v_add_f32 v28, v28, v40
v_add_f32 v52, v52, v64
v_add_f32 v29, v29, v41
v_add_f32 v53, v53, v65
v_add_f32 v30, v30, v42
v_add_f32 v54, v54, v66
v_add_f32 v32, v32, v44
v_add_f32 v56, v56, v68
v_add_f32 v33, v33, v45
v_add_f32 v57, v57, v69
v_add_f32 v24, v24, v48
v_add_f32 v25, v25, v49
v_add_f32 v26, v26, v50
v_add_f32 v28, v28, v52
v_add_f32 v29, v29, v53
v_add_f32 v30, v30, v54
v_add_f32 v32, v32, v56
v_add_f32 v33, v33, v57
v_cvt_pk_bf16_f32 v36, v24, v25
v_cvt_pk_bf16_f32 v37, v26, v28
v_cvt_pk_bf16_f32 v38, v29, v30
v_cvt_pk_bf16_f32 v39, v32, v33
ds_write_b128 v4, v[36:39] offset:1280
v_cmp_ne_u32 vcc, 0, v5
s_cmp_eq_u64 vcc, 0
s_cselect_b32 s8, 2, 1
v_mov_b32 v6, s8
s_mov_b64 exec, 1
ds_write_b32 v3, v6 offset:8
s_mov_b64 exec, -1
s_cmp_lg_u32 s80, 0
s_cbranch_scc1 L_q_bdone2
s_mov_b64 exec, 0xff
s_add_u32 s11, s82, 262144
buffer_store_dwordx4 v[12:15], v4, s[52:55], s11 offen offset:0 sc1
buffer_store_dwordx4 v[16:19], v4, s[52:55], s11 offen offset:128 sc1
buffer_store_dwordx4 v[20:23], v4, s[52:55], s11 offen offset:256 sc1
s_mov_b64 exec, -1
s_mov_b32 s80, 1
L_q_bdone2:
s_endpgm
L_others:
s_cmp_eq_u32 s3, 10
s_cbranch_scc1 L_roleW
s_cmp_eq_u32 s3, 9
s_cbranch_scc1 L_roleF
s_lshr_b32 s8, s5, 2
s_mul_i32 s9, s4, 5
s_add_u32 s8, s8, s9
s_and_b32 s9, s5, 3
s_lshl_b32 s9, s9, 2
s_add_u32 s8, s8, s9
s_and_b32 s6, s8, 15
s_and_b32 s76, s6, 7
s_lshr_b32 s8, s6, 2
s_lshl_b32 s8, s8, 3
s_or_b32 s76, s76, s8
s_lshr_b32 s8, s6, 3
s_lshl_b32 s8, s8, 6
s_or_b32 s76, s76, s8
s_and_b32 s77, s6, 3
s_add_u32 s8, s5, s4
s_and_b32 s78, s8, 3
s_cmp_ge_u32 s3, 5
s_cbranch_scc1 L_roleV
L_roleK:
s_sub_u32 s80, s3, 1
s_and_b32 s8, s76, 7
v_and_b32 v2, 7, v0
v_xor_b32 v2, s8, v2
v_lshlrev_b32 v2, 9, v2
v_lshrrev_b32 v3, 3, v0
v_lshl_or_b32 v2, v3, 4, v2
v_mov_b32 v4, 0
v_mov_b32 v5, 1
v_and_b32 v6, 1, v0
v_lshlrev_b32 v6, 9, v6
v_bfe_u32 v7, v0, 1, 1
v_lshrrev_b32 v8, 4, v0
v_lshl_add_u32 v7, v8, 1, v7
v_lshl_add_u32 v6, v7, 4, v6
v_bfe_u32 v9, v0, 1, 1
v_lshlrev_b32 v9, 10, v9
v_and_b32 v10, 1, v0
v_lshl_or_b32 v9, v10, 9, v9
v_bfe_u32 v10, v0, 4, 1
v_lshl_or_b32 v9, v10, 4, v9
s_lshl_b32 s8, s80, 7
v_add_u32 v9, s8, v9
s_and_b32 s81, s76, 0x78
s_lshl_b32 s82, s80, 5
s_lshl_b32 s8, s4, 25
s_lshl_b32 s9, s5, 16
s_add_u32 s8, s8, s9
s_add_u32 s8, s8, 0x1E00000
s_mov_b32 s83, s8
s_waitcnt lgkmcnt(0)
s_add_u32 s44, s18, s83
s_addc_u32 s45, s19, 0
s_and_b32 s45, s45, 0xffff
s_mov_b32 s46, 65536
s_mov_b32 s47, 0x20000
s_mov_b32 s52, s40
s_and_b32 s53, s41, 0xffff
s_mov_b32 s54, 134217728
s_mov_b32 s55, 0x20000
s_add_u32 s10, s82, 0
s_xor_b32 s10, s10, s81
s_lshl_b32 s10, s10, 9
s_xor_b32 s9, s77, 0
s_lshl_b32 s9, s9, 7
s_or_b32 s16, s9, s10
s_xor_b32 s9, s77, 1
s_lshl_b32 s9, s9, 7
s_or_b32 s17, s9, s10
s_xor_b32 s9, s77, 2
s_lshl_b32 s9, s9, 7
s_or_b32 s18, s9, s10
s_xor_b32 s9, s77, 3
s_lshl_b32 s9, s9, 7
s_or_b32 s19, s9, s10
s_add_u32 s10, s82, 8
s_xor_b32 s10, s10, s81
s_lshl_b32 s10, s10, 9
s_xor_b32 s9, s77, 0
s_lshl_b32 s9, s9, 7
s_or_b32 s20, s9, s10
s_xor_b32 s9, s77, 1
s_lshl_b32 s9, s9, 7
s_or_b32 s21, s9, s10
s_xor_b32 s9, s77, 2
s_lshl_b32 s9, s9, 7
s_or_b32 s22, s9, s10
s_xor_b32 s9, s77, 3
s_lshl_b32 s9, s9, 7
s_or_b32 s23, s9, s10
s_add_u32 s10, s82, 16
s_xor_b32 s10, s10, s81
s_lshl_b32 s10, s10, 9
s_xor_b32 s9, s77, 0
s_lshl_b32 s9, s9, 7
s_or_b32 s24, s9, s10
s_xor_b32 s9, s77, 1
s_lshl_b32 s9, s9, 7
s_or_b32 s25, s9, s10
s_xor_b32 s9, s77, 2
s_lshl_b32 s9, s9, 7
s_or_b32 s26, s9, s10
s_xor_b32 s9, s77, 3
s_lshl_b32 s9, s9, 7
s_or_b32 s27, s9, s10
s_add_u32 s10, s82, 24
s_xor_b32 s10, s10, s81
s_lshl_b32 s10, s10, 9
s_xor_b32 s9, s77, 0
s_lshl_b32 s9, s9, 7
s_or_b32 s28, s9, s10
s_xor_b32 s9, s77, 1
s_lshl_b32 s9, s9, 7
s_or_b32 s29, s9, s10
s_xor_b32 s9, s77, 2
s_lshl_b32 s9, s9, 7
s_or_b32 s30, s9, s10
s_xor_b32 s9, s77, 3
s_lshl_b32 s9, s9, 7
s_or_b32 s31, s9, s10
v_mov_b32 v12, 48
s_mov_b32 s12, 0
L_lw_3:
ds_read_b32 v11, v4 offset:56
s_waitcnt lgkmcnt(0)
v_readfirstlane_b32 s8, v11
s_cmp_ge_u32 s8, 1
s_cbranch_scc1 L_lwd_4
s_sleep 1
s_add_u32 s12, s12, 1
s_cmp_lt_u32 s12, 2400000
s_cbranch_scc1 L_lw_3
L_lwd_4:
L_issue16:
buffer_load_dwordx4 v[16:19], v2, s[44:47], s16 offen nt
buffer_load_dwordx4 v[20:23], v2, s[44:47], s17 offen nt
s_mov_b32 s12, 0
L_lw_5:
ds_read_b32 v11, v12 offset:0
s_waitcnt lgkmcnt(0)
v_readfirstlane_b32 s8, v11
s_cmp_ge_u32 s8, 1
s_cbranch_scc1 L_lwd_6
s_sleep 1
s_add_u32 s12, s12, 1
s_cmp_lt_u32 s12, 2400000
s_cbranch_scc1 L_lw_5
L_lwd_6:
buffer_load_dwordx4 v[24:27], v2, s[44:47], s18 offen nt
buffer_load_dwordx4 v[28:31], v2, s[44:47], s19 offen nt
buffer_load_dwordx4 v[32:35], v2, s[44:47], s20 offen nt
buffer_load_dwordx4 v[36:39], v2, s[44:47], s21 offen nt
s_waitcnt vmcnt(5)
buffer_load_dwordx4 v[40:43], v2, s[44:47], s22 offen nt
s_waitcnt vmcnt(5)
buffer_load_dwordx4 v[44:47], v2, s[44:47], s23 offen nt
s_waitcnt vmcnt(5)
buffer_load_dwordx4 v[48:51], v2, s[44:47], s24 offen nt
s_waitcnt vmcnt(5)
buffer_load_dwordx4 v[52:55], v2, s[44:47], s25 offen nt
s_waitcnt vmcnt(5)
buffer_load_dwordx4 v[56:59], v2, s[44:47], s26 offen nt
s_waitcnt vmcnt(5)
buffer_load_dwordx4 v[60:63], v2, s[44:47], s27 offen nt
s_waitcnt vmcnt(5)
buffer_load_dwordx4 v[64:67], v2, s[44:47], s28 offen nt
s_waitcnt vmcnt(5)
buffer_load_dwordx4 v[68:71], v2, s[44:47], s29 offen nt
s_waitcnt vmcnt(5)
buffer_load_dwordx4 v[72:75], v2, s[44:47], s30 offen nt
s_waitcnt vmcnt(5)
buffer_load_dwordx4 v[76:79], v2, s[44:47], s31 offen nt
s_cmp_ge_u32 s3, 9
s_cbranch_scc1 L_w_issued
s_cmp_ge_u32 s3, 5
s_cbranch_scc1 L_v_issued
s_mov_b64 exec, 1
ds_add_u32 v4, v5 offset:0
s_mov_b64 exec, -1
s_waitcnt vmcnt(5)
s_mov_b64 exec, 1
ds_add_u32 v4, v5 offset:32
s_mov_b64 exec, -1
s_mov_b32 s12, 0
L_lw_7:
ds_read_b32 v11, v4 offset:8
s_waitcnt lgkmcnt(0)
v_readfirstlane_b32 s8, v11
s_cmp_ge_u32 s8, 1
s_cbranch_scc1 L_lwd_8
s_sleep 1
s_add_u32 s12, s12, 1
s_cmp_lt_u32 s12, 2400000
s_cbranch_scc1 L_lw_7
L_lwd_8:
s_mov_b32 s15, s8
s_xor_b32 s9, s77, 0
s_lshl_b32 s9, s9, 7
s_add_u32 s9, s9, 1280
v_add_u32 v11, s9, v6
ds_read_b128 v[80:83], v11
s_xor_b32 s9, s77, 1
s_lshl_b32 s9, s9, 7
s_add_u32 s9, s9, 1280
v_add_u32 v11, s9, v6
ds_read_b128 v[84:87], v11
s_xor_b32 s9, s77, 2
s_lshl_b32 s9, s9, 7
s_add_u32 s9, s9, 1280
v_add_u32 v11, s9, v6
ds_read_b128 v[88:91], v11
s_xor_b32 s9, s77, 3
s_lshl_b32 s9, s9, 7
s_add_u32 s9, s9, 1280
v_add_u32 v11, s9, v6
ds_read_b128 v[92:95], v11
s_waitcnt vmcnt(0) lgkmcnt(0)
v_mfma_f32_16x16x32_bf16 v[96:99], v[16:19], v[80:83], 0
v_mfma_f32_16x16x32_bf16 v[100:103], v[32:35], v[80:83], 0
v_mfma_f32_16x16x32_bf16 v[104:107], v[48:51], v[80:83], 0
v_mfma_f32_16x16x32_bf16 v[108:111], v[64:67], v[80:83], 0
v_mfma_f32_16x16x32_bf16 v[96:99], v[20:23], v[84:87], v[96:99]
v_mfma_f32_16x16x32_bf16 v[100:103], v[36:39], v[84:87], v[100:103]
v_mfma_f32_16x16x32_bf16 v[104:107], v[52:55], v[84:87], v[104:107]
v_mfma_f32_16x16x32_bf16 v[108:111], v[68:71], v[84:87], v[108:111]
v_mfma_f32_16x16x32_bf16 v[96:99], v[24:27], v[88:91], v[96:99]
v_mfma_f32_16x16x32_bf16 v[100:103], v[40:43], v[88:91], v[100:103]
v_mfma_f32_16x16x32_bf16 v[104:107], v[56:59], v[88:91], v[104:107]
v_mfma_f32_16x16x32_bf16 v[108:111], v[72:75], v[88:91], v[108:111]
v_mfma_f32_16x16x32_bf16 v[96:99], v[28:31], v[92:95], v[96:99]
v_mfma_f32_16x16x32_bf16 v[100:103], v[44:47], v[92:95], v[100:103]
v_mfma_f32_16x16x32_bf16 v[104:107], v[60:63], v[92:95], v[104:107]
v_mfma_f32_16x16x32_bf16 v[108:111], v[76:79], v[92:95], v[108:111]
s_nop 7
s_mov_b32 exec_lo, 0x00030003
s_mov_b32 exec_hi, 0x000C000C
ds_write_b128 v9, v[96:99] offset:2304
ds_write_b128 v9, v[100:103] offset:2336
ds_write_b128 v9, v[104:107] offset:2368
ds_write_b128 v9, v[108:111] offset:2400
s_mov_b64 exec, -1
s_mov_b64 exec, 1
ds_add_u32 v4, v5 offset:12
s_mov_b64 exec, -1
s_cmp_lg_u32 s80, 0
s_cbranch_scc1 L_k_nosoft
v_lshrrev_b32 v6, 5, v0
v_and_b32 v7, 31, v0
v_lshlrev_b32 v8, 9, v6
v_lshl_add_u32 v8, v7, 4, v8
v_lshlrev_b32 v9, 8, v6
v_lshl_add_u32 v16, v7, 3, v9
s_mov_b32 s10, 0x3db8aa3b
s_lshl_b32 s9, s4, 9
s_lshl_b32 s11, s5, 3
s_add_u32 s9, s9, s11
s_add_u32 s81, s9, 8192
s_mov_b32 s12, 0
L_lw_9:
ds_read_b32 v11, v4 offset:12
s_waitcnt lgkmcnt(0)
v_readfirstlane_b32 s8, v11
s_cmp_ge_u32 s8, 4
s_cbranch_scc1 L_lwd_10
s_add_u32 s12, s12, 1
s_cmp_lt_u32 s12, 2400000
s_cbranch_scc1 L_lw_9
L_lwd_10:
ds_read_b128 v[20:23], v8 offset:2304
ds_read_b128 v[24:27], v8 offset:3328
s_waitcnt lgkmcnt(0)
v_add_f32 v20, v20, v24
v_add_f32 v21, v21, v25
v_add_f32 v22, v22, v26
v_add_f32 v23, v23, v27
v_cvt_pk_bf16_f32 v24, v20, v21
v_cvt_pk_bf16_f32 v25, v22, v23
v_lshlrev_b32 v20, 16, v24
v_and_b32 v21, 0xffff0000, v24
v_lshlrev_b32 v22, 16, v25
v_and_b32 v23, 0xffff0000, v25
v_max3_f32 v10, v20, v21, v22
v_max_f32 v10, v10, v23
s_nop 1
v_max_f32_dpp v10, v10, v10 row_ror:8 row_mask:0xf bank_mask:0xf
s_nop 1
v_max_f32_dpp v10, v10, v10 row_ror:4 row_mask:0xf bank_mask:0xf
s_nop 1
v_max_f32_dpp v10, v10, v10 row_ror:2 row_mask:0xf bank_mask:0xf
s_nop 1
v_max_f32_dpp v10, v10, v10 row_ror:1 row_mask:0xf bank_mask:0xf
v_mov_b32 v11, v10
s_nop 1
v_permlane16_swap_b32 v10, v11
s_nop 1
v_max_f32 v10, v10, v11
v_sub_f32 v20, v20, v10
v_sub_f32 v21, v21, v10
v_sub_f32 v22, v22, v10
v_sub_f32 v23, v23, v10
v_mul_f32 v20, s10, v20
v_mul_f32 v21, s10, v21
v_mul_f32 v22, s10, v22
v_mul_f32 v23, s10, v23
v_exp_f32 v20, v20
v_exp_f32 v21, v21
v_exp_f32 v22, v22
v_exp_f32 v23, v23
s_nop 0
v_cvt_pk_bf16_f32 v24, v20, v21
v_cvt_pk_bf16_f32 v25, v22, v23
ds_write_b64 v16, v[24:25] offset:4864
s_mov_b64 exec, 1
ds_add_u32 v4, v5 offset:52
s_mov_b64 exec, -1
v_add_f32 v11, v20, v21
v_add_f32 v12, v22, v23
v_add_f32 v11, v11, v12
s_nop 1
v_add_f32_dpp v11, v11, v11 row_ror:8 row_mask:0xf bank_mask:0xf
s_nop 1
v_add_f32_dpp v11, v11, v11 row_ror:4 row_mask:0xf bank_mask:0xf
s_nop 1
v_add_f32_dpp v11, v11, v11 row_ror:2 row_mask:0xf bank_mask:0xf
s_nop 1
v_add_f32_dpp v11, v11, v11 row_ror:1 row_mask:0xf bank_mask:0xf
v_mov_b32 v12, v11
s_nop 1
v_permlane16_swap_b32 v11, v12
s_nop 1
v_add_f32 v11, v11, v12
v_mul_f32 v10, s10, v10
s_mov_b32 exec_lo, 1
s_mov_b32 exec_hi, 1
s_cmp_eq_u32 s15, 2
s_cbranch_scc1 L_k_mlfast
s_mov_b64 exec, -1
s_mov_b32 s12, 0
L_lw_11:
ds_read_b32 v13, v4 offset:60
s_waitcnt lgkmcnt(0)
v_readfirstlane_b32 s8, v13
s_cmp_ge_u32 s8, 1
s_cbranch_scc1 L_lwd_12
s_sleep 1
s_add_u32 s12, s12, 1
s_cmp_lt_u32 s12, 2400000
s_cbranch_scc1 L_lw_11
L_lwd_12:
s_mov_b32 exec_lo, 1
s_mov_b32 exec_hi, 1
buffer_store_dwordx2 v[10:11], v9, s[52:55], s81 offen sc1
s_branch L_k_mldone
L_k_mlfast:
buffer_store_dwordx2 v[10:11], v9, s[52:55], s81 offen
L_k_mldone:
s_mov_b64 exec, -1
L_k_nosoft:
s_cmp_ge_u32 s5, 28
s_cbranch_scc1 L_k_end
s_and_b32 s81, s5, 3
ds_read_b32 v12, v4 offset:72
v_and_b32 v13, 31, v0
v_lshlrev_b32 v13, 2, v13
s_lshl_b32 s8, s4, 7
s_add_u32 s82, s8, 4096
v_lshlrev_b32 v14, 1, v13
s_lshr_b32 s8, s81, 1
s_lshl_b32 s9, s4, 1
s_add_u32 s8, s8, s9
s_lshl_b32 s8, s8, 8
s_add_u32 s84, s8, 8192
v_lshrrev_b32 v15, 3, v0
v_lshlrev_b32 v16, 11, v15
v_and_b32 v17, 7, v0
v_lshl_add_u32 v16, v17, 4, v16
s_lshl_b32 s8, s4, 16
s_lshl_b32 s9, s81, 9
s_add_u32 s8, s8, s9
s_lshl_b32 s9, s80, 7
s_add_u32 s8, s8, s9
s_add_u32 s85, s8, 589824
v_lshlrev_b32 v15, 2, v15
v_lshlrev_b32 v18, 2, v17
v_bfe_u32 v19, v0, 5, 1
v_lshl_add_u32 v18, v19, 1, v18
v_bfe_u32 v19, v0, 4, 1
v_add_u32 v18, v18, v19
v_lshlrev_b32 v18, 1, v18
s_lshl_b32 s8, s80, 6
v_add_u32 v18, s8, v18
s_cmp_lg_u32 s80, 1
s_cbranch_scc1 L_k_wwait
s_waitcnt lgkmcnt(0)
s_mov_b32 s12, 0
L_k_rdy:
buffer_load_dword v20, v13, s[52:55], s82 offen sc1
s_waitcnt vmcnt(0)
v_xor_b32 v20, v20, v12
s_cmp_eq_u32 s15, 2
s_cbranch_scc1 L_k_rdy_f
v_cmp_ne_u32 vcc, 1, v20
s_branch L_k_rdy_c
L_k_rdy_f:
v_cmp_lt_u32 vcc, 7, v20
L_k_rdy_c:
s_cmp_eq_u64 vcc, 0
s_cbranch_scc1 L_k_rdy_ok
s_sleep 4
s_add_u32 s12, s12, 1
s_cmp_lt_u32 s12, 600000
s_cbranch_scc1 L_k_rdy
L_k_rdy_ok:
s_mov_b32 s12, 0
L_lw_13:
ds_read_b32 v11, v4 offset:52
s_waitcnt lgkmcnt(0)
v_readfirstlane_b32 s8, v11
s_cmp_ge_u32 s8, 1
s_cbranch_scc1 L_lwd_14
s_sleep 1
s_add_u32 s12, s12, 1
s_cmp_lt_u32 s12, 2400000
s_cbranch_scc1 L_lw_13
L_lwd_14:
s_sleep 8
s_mov_b32 s12, 0
buffer_load_dwordx2 v[20:21], v14, s[52:55], s84 offen sc1
s_sleep 12
buffer_load_dwordx2 v[48:49], v14, s[52:55], s84 offen sc1
L_mlpoll:
s_waitcnt vmcnt(1)
v_max_u32 v22, v20, v21
v_cmp_eq_u32 vcc, -1, v22
s_cmp_eq_u64 vcc, 0
s_cbranch_scc1 L_mlgot
buffer_load_dwordx2 v[20:21], v14, s[52:55], s84 offen sc1
s_waitcnt vmcnt(1)
v_max_u32 v22, v48, v49
v_cmp_eq_u32 vcc, -1, v22
s_cmp_eq_u64 vcc, 0
s_cbranch_scc1 L_mlgot2
buffer_load_dwordx2 v[48:49], v14, s[52:55], s84 offen sc1
s_add_u32 s12, s12, 1
s_cmp_lt_u32 s12, 600000
s_cbranch_scc1 L_mlpoll
L_mlgot2:
s_waitcnt vmcnt(0)
v_mov_b32 v20, v48
v_mov_b32 v21, v49
L_mlgot:
s_waitcnt vmcnt(0)
v_mov_b32 v22, v20
s_nop 1
v_max_f32_dpp v22, v22, v22 row_ror:8 row_mask:0xf bank_mask:0xf
s_nop 1
v_max_f32_dpp v22, v22, v22 row_ror:4 row_mask:0xf bank_mask:0xf
s_nop 1
v_max_f32_dpp v22, v22, v22 row_ror:2 row_mask:0xf bank_mask:0xf
s_nop 1
v_max_f32_dpp v22, v22, v22 row_ror:1 row_mask:0xf bank_mask:0xf
v_mov_b32 v23, v22
s_nop 1
v_permlane16_swap_b32 v22, v23
s_nop 1
v_max_f32 v22, v22, v23
v_sub_f32 v20, v20, v22
v_exp_f32 v20, v20
s_nop 0
v_mul_f32 v21, v20, v21
s_nop 1
v_add_f32_dpp v21, v21, v21 row_ror:8 row_mask:0xf bank_mask:0xf
s_nop 1
v_add_f32_dpp v21, v21, v21 row_ror:4 row_mask:0xf bank_mask:0xf
s_nop 1
v_add_f32_dpp v21, v21, v21 row_ror:2 row_mask:0xf bank_mask:0xf
s_nop 1
v_add_f32_dpp v21, v21, v21 row_ror:1 row_mask:0xf bank_mask:0xf
v_mov_b32 v23, v21
s_nop 1
v_permlane16_swap_b32 v21, v23
s_nop 1
v_add_f32 v21, v21, v23
v_rcp_f32 v21, v21
s_nop 0
v_mul_f32 v20, v20, v21
s_mov_b32 exec_hi, 0
ds_write_b32 v13, v20 offset:5376
s_mov_b64 exec, -1
s_mov_b64 exec, 1
ds_add_u32 v4, v5 offset:68
s_mov_b64 exec, -1
L_k_wwait:
s_mov_b32 s12, 0
L_lw_15:
ds_read_b32 v11, v4 offset:68
s_waitcnt lgkmcnt(0)
v_readfirstlane_b32 s8, v11
s_cmp_ge_u32 s8, 1
s_cbranch_scc1 L_lwd_16
s_sleep 1
s_add_u32 s12, s12, 1
s_cmp_lt_u32 s12, 2400000
s_cbranch_scc1 L_lw_15
L_lwd_16:
ds_read_b32 v24, v15 offset:5376
ds_read_b32 v25, v15 offset:5408
ds_read_b32 v26, v15 offset:5440
ds_read_b32 v27, v15 offset:5472
s_mov_b32 s12, 0
L_lw_17:
ds_read_b32 v11, v4 offset:44
s_waitcnt lgkmcnt(0)
v_readfirstlane_b32 s8, v11
s_cmp_ge_u32 s8, 4
s_cbranch_scc1 L_lwd_18
s_add_u32 s12, s12, 1
s_cmp_lt_u32 s12, 2400000
s_cbranch_scc1 L_lw_17
L_lwd_18:
s_mov_b32 s12, 0
s_add_u32 s9, s85, 0
buffer_load_dwordx4 v[32:35], v16, s[52:55], s9 offen sc1
s_add_u32 s9, s85, 16384
buffer_load_dwordx4 v[36:39], v16, s[52:55], s9 offen sc1
s_add_u32 s9, s85, 32768
buffer_load_dwordx4 v[40:43], v16, s[52:55], s9 offen sc1
s_add_u32 s9, s85, 49152
buffer_load_dwordx4 v[44:47], v16, s[52:55], s9 offen sc1
s_sleep 2
s_add_u32 s9, s85, 0
buffer_load_dwordx4 v[48:51], v16, s[52:55], s9 offen sc1
s_add_u32 s9, s85, 16384
buffer_load_dwordx4 v[52:55], v16, s[52:55], s9 offen sc1
s_add_u32 s9, s85, 32768
buffer_load_dwordx4 v[56:59], v16, s[52:55], s9 offen sc1
s_add_u32 s9, s85, 49152
buffer_load_dwordx4 v[60:63], v16, s[52:55], s9 offen sc1
L_opoll:
s_waitcnt vmcnt(7)
v_mul_f32 v28, v24, v32
v_mul_f32 v29, v24, v33
v_mul_f32 v30, v24, v34
v_mul_f32 v31, v24, v35
s_waitcnt vmcnt(6)
v_fmac_f32 v28, v25, v36
v_fmac_f32 v29, v25, v37
v_fmac_f32 v30, v25, v38
v_fmac_f32 v31, v25, v39
s_waitcnt vmcnt(5)
v_fmac_f32 v28, v26, v40
v_fmac_f32 v29, v26, v41
v_fmac_f32 v30, v26, v42
v_fmac_f32 v31, v26, v43
s_waitcnt vmcnt(4)
v_fmac_f32 v28, v27, v44
v_fmac_f32 v29, v27, v45
v_fmac_f32 v30, v27, v46
v_fmac_f32 v31, v27, v47
v_add_f32 v22, v28, v29
v_add_f32 v22, v22, v30
v_add_f32 v22, v22, v31
v_cmp_u_f32 vcc, v22, v22
s_cmp_eq_u64 vcc, 0
s_cbranch_scc1 L_ogot
v_max_u32 v22, v32, v33
v_max3_u32 v22, v22, v34, v35
v_max3_u32 v22, v22, v36, v37
v_max3_u32 v22, v22, v38, v39
v_max3_u32 v22, v22, v40, v41
v_max3_u32 v22, v22, v42, v43
v_max3_u32 v22, v22, v44, v45
v_max3_u32 v22, v22, v46, v47
v_cmp_eq_u32 vcc, -1, v22
s_cmp_eq_u64 vcc, 0
s_cbranch_scc1 L_ogot
s_add_u32 s9, s85, 0
buffer_load_dwordx4 v[32:35], v16, s[52:55], s9 offen sc1
s_add_u32 s9, s85, 16384
buffer_load_dwordx4 v[36:39], v16, s[52:55], s9 offen sc1
s_add_u32 s9, s85, 32768
buffer_load_dwordx4 v[40:43], v16, s[52:55], s9 offen sc1
s_add_u32 s9, s85, 49152
buffer_load_dwordx4 v[44:47], v16, s[52:55], s9 offen sc1
s_waitcnt vmcnt(7)
v_mul_f32 v28, v24, v48
v_mul_f32 v29, v24, v49
v_mul_f32 v30, v24, v50
v_mul_f32 v31, v24, v51
s_waitcnt vmcnt(6)
v_fmac_f32 v28, v25, v52
v_fmac_f32 v29, v25, v53
v_fmac_f32 v30, v25, v54
v_fmac_f32 v31, v25, v55
s_waitcnt vmcnt(5)
v_fmac_f32 v28, v26, v56
v_fmac_f32 v29, v26, v57
v_fmac_f32 v30, v26, v58
v_fmac_f32 v31, v26, v59
s_waitcnt vmcnt(4)
v_fmac_f32 v28, v27, v60
v_fmac_f32 v29, v27, v61
v_fmac_f32 v30, v27, v62
v_fmac_f32 v31, v27, v63
v_add_f32 v22, v28, v29
v_add_f32 v22, v22, v30
v_add_f32 v22, v22, v31
v_cmp_u_f32 vcc, v22, v22
s_cmp_eq_u64 vcc, 0
s_cbranch_scc1 L_ogot
v_max_u32 v22, v48, v49
v_max3_u32 v22, v22, v50, v51
v_max3_u32 v22, v22, v52, v53
v_max3_u32 v22, v22, v54, v55
v_max3_u32 v22, v22, v56, v57
v_max3_u32 v22, v22, v58, v59
v_max3_u32 v22, v22, v60, v61
v_max3_u32 v22, v22, v62, v63
v_cmp_eq_u32 vcc, -1, v22
s_cmp_eq_u64 vcc, 0
s_cbranch_scc1 L_ogot
s_add_u32 s9, s85, 0
buffer_load_dwordx4 v[48:51], v16, s[52:55], s9 offen sc1
s_add_u32 s9, s85, 16384
buffer_load_dwordx4 v[52:55], v16, s[52:55], s9 offen sc1
s_add_u32 s9, s85, 32768
buffer_load_dwordx4 v[56:59], v16, s[52:55], s9 offen sc1
s_add_u32 s9, s85, 49152
buffer_load_dwordx4 v[60:63], v16, s[52:55], s9 offen sc1
s_add_u32 s12, s12, 1
s_cmp_lt_u32 s12, 600000
s_cbranch_scc1 L_opoll
L_ogot:
v_permlane32_swap_b32 v28, v30
v_permlane32_swap_b32 v29, v31
s_nop 1
v_add_f32 v28, v28, v30
v_add_f32 v29, v29, v31
s_nop 1
v_permlane16_swap_b32 v28, v29
s_nop 1
v_add_f32 v28, v28, v29
s_nop 1
v_add_f32_dpp v28, v28, v28 row_ror:8 row_mask:0xf bank_mask:0xf
v_cvt_pk_bf16_f32 v28, v28, v28
ds_write_b16 v18, v28 offset:4352
s_mov_b64 exec, 1
ds_add_u32 v4, v5 offset:24
s_mov_b64 exec, -1
L_k_end:
s_endpgm
L_roleV:
s_sub_u32 s80, s3, 5
s_xor_b32 s83, s80, s78
s_and_b32 s8, s76, 0x38
v_and_b32 v2, 0x38, v0
v_xor_b32 v2, s8, v2
v_lshlrev_b32 v2, 9, v2
v_and_b32 v3, 7, v0
v_lshl_or_b32 v2, v3, 4, v2
s_lshl_b32 s8, s83, 7
v_add_u32 v2, s8, v2
v_mov_b32 v4, 0
v_mov_b32 v5, 1
v_and_b32 v6, 1, v0
v_lshlrev_b32 v6, 9, v6
v_bfe_u32 v7, v0, 1, 1
v_lshrrev_b32 v8, 4, v0
v_lshl_add_u32 v7, v8, 1, v7
v_lshl_add_u32 v6, v7, 5, v6
v_and_b32 v9, 7, v0
v_lshlrev_b32 v9, 5, v9
s_lshl_b32 s8, s83, 8
v_add_u32 v9, s8, v9
s_lshl_b32 s8, s4, 5
s_add_u32 s8, s8, s5
s_lshl_b32 s8, s8, 11
s_add_u32 s82, s8, 589824
s_and_b32 s81, s76, 0x47
s_lshl_b32 s8, s4, 25
s_lshl_b32 s9, s5, 16
s_add_u32 s8, s8, s9
s_add_u32 s8, s8, 0x1E00000
s_mov_b32 s84, s8
s_waitcnt lgkmcnt(0)
s_add_u32 s44, s20, s84
s_addc_u32 s45, s21, 0
s_and_b32 s45, s45, 0xffff
s_mov_b32 s46, 65536
s_mov_b32 s47, 0x20000
s_mov_b32 s52, s40
s_and_b32 s53, s41, 0xffff
s_mov_b32 s54, 134217728
s_mov_b32 s55, 0x20000
s_lshl_b32 s8, s4, 2
s_add_u32 s8, s8, s83
s_lshl_b32 s8, s8, 7
s_lshl_b32 s9, s5, 2
s_add_u32 s8, s8, s9
s_add_u32 s85, s8, 1245184
s_xor_b32 s9, s81, 0
s_lshl_b32 s16, s9, 9
s_xor_b32 s9, s81, 1
s_lshl_b32 s17, s9, 9
s_xor_b32 s9, s81, 2
s_lshl_b32 s18, s9, 9
s_xor_b32 s9, s81, 3
s_lshl_b32 s19, s9, 9
s_xor_b32 s9, s81, 4
s_lshl_b32 s20, s9, 9
s_xor_b32 s9, s81, 5
s_lshl_b32 s21, s9, 9
s_xor_b32 s9, s81, 6
s_lshl_b32 s22, s9, 9
s_xor_b32 s9, s81, 7
s_lshl_b32 s23, s9, 9
s_xor_b32 s9, s81, 64
s_lshl_b32 s24, s9, 9
s_xor_b32 s9, s81, 65
s_lshl_b32 s25, s9, 9
s_xor_b32 s9, s81, 66
s_lshl_b32 s26, s9, 9
s_xor_b32 s9, s81, 67
s_lshl_b32 s27, s9, 9
s_xor_b32 s9, s81, 68
s_lshl_b32 s28, s9, 9
s_xor_b32 s9, s81, 69
s_lshl_b32 s29, s9, 9
s_xor_b32 s9, s81, 70
s_lshl_b32 s30, s9, 9
s_xor_b32 s9, s81, 71
s_lshl_b32 s31, s9, 9
v_mov_b32 v12, 36
s_mov_b32 s12, 0
L_lw_19:
ds_read_b32 v11, v4 offset:36
s_waitcnt lgkmcnt(0)
v_readfirstlane_b32 s8, v11
s_cmp_ge_u32 s8, 1
s_cbranch_scc1 L_lwd_20
s_sleep 1
s_add_u32 s12, s12, 1
s_cmp_lt_u32 s12, 2400000
s_cbranch_scc1 L_lw_19
L_lwd_20:
s_branch L_issue16
L_v_issued:
s_mov_b64 exec, 1
ds_add_u32 v4, v5 offset:4
s_mov_b64 exec, -1
v_and_b32 v10, 1, v0
v_lshlrev_b32 v10, 8, v10
v_bfe_u32 v11, v0, 1, 1
v_lshrrev_b32 v14, 4, v0
v_lshl_add_u32 v11, v14, 1, v11
v_lshl_add_u32 v10, v11, 4, v10
s_waitcnt vmcnt(8)
v_perm_b32 v80, v20, v16, s13
v_perm_b32 v84, v20, v16, s14
v_perm_b32 v88, v21, v17, s13
v_perm_b32 v92, v21, v17, s14
v_perm_b32 v96, v22, v18, s13
v_perm_b32 v100, v22, v18, s14
v_perm_b32 v104, v23, v19, s13
v_perm_b32 v108, v23, v19, s14
v_perm_b32 v81, v28, v24, s13
v_perm_b32 v85, v28, v24, s14
v_perm_b32 v89, v29, v25, s13
v_perm_b32 v93, v29, v25, s14
v_perm_b32 v97, v30, v26, s13
v_perm_b32 v101, v30, v26, s14
v_perm_b32 v105, v31, v27, s13
v_perm_b32 v109, v31, v27, s14
v_perm_b32 v82, v36, v32, s13
v_perm_b32 v86, v36, v32, s14
v_perm_b32 v90, v37, v33, s13
v_perm_b32 v94, v37, v33, s14
v_perm_b32 v98, v38, v34, s13
v_perm_b32 v102, v38, v34, s14
v_perm_b32 v106, v39, v35, s13
v_perm_b32 v110, v39, v35, s14
v_perm_b32 v83, v44, v40, s13
v_perm_b32 v87, v44, v40, s14
v_perm_b32 v91, v45, v41, s13
v_perm_b32 v95, v45, v41, s14
v_perm_b32 v99, v46, v42, s13
v_perm_b32 v103, v46, v42, s14
v_perm_b32 v107, v47, v43, s13
v_perm_b32 v111, v47, v43, s14
ds_read_b32 v11, v4 offset:52
ds_read_b32 v12, v4 offset:8
ds_read_b128 v[144:147], v10 offset:4864
ds_read_b128 v[148:151], v10 offset:4992
s_waitcnt lgkmcnt(0)
v_readfirstlane_b32 s81, v11
v_readfirstlane_b32 s15, v12
s_cmp_eq_u32 s81, 0
s_cbranch_scc1 L_v_late
v_mfma_f32_16x16x32_bf16 v[16:19], v[144:147], v[80:83], 0
v_mfma_f32_16x16x32_bf16 v[20:23], v[144:147], v[84:87], 0
v_mfma_f32_16x16x32_bf16 v[24:27], v[144:147], v[88:91], 0
v_mfma_f32_16x16x32_bf16 v[28:31], v[144:147], v[92:95], 0
v_mfma_f32_16x16x32_bf16 v[32:35], v[144:147], v[96:99], 0
v_mfma_f32_16x16x32_bf16 v[36:39], v[144:147], v[100:103], 0
v_mfma_f32_16x16x32_bf16 v[40:43], v[144:147], v[104:107], 0
v_mfma_f32_16x16x32_bf16 v[44:47], v[144:147], v[108:111], 0
s_waitcnt vmcnt(6)
v_perm_b32 v112, v52, v48, s13
v_perm_b32 v116, v52, v48, s14
v_perm_b32 v120, v53, v49, s13
v_perm_b32 v124, v53, v49, s14
v_perm_b32 v128, v54, v50, s13
v_perm_b32 v132, v54, v50, s14
v_perm_b32 v136, v55, v51, s13
v_perm_b32 v140, v55, v51, s14
s_waitcnt vmcnt(4)
v_perm_b32 v113, v60, v56, s13
v_perm_b32 v117, v60, v56, s14
v_perm_b32 v121, v61, v57, s13
v_perm_b32 v125, v61, v57, s14
v_perm_b32 v129, v62, v58, s13
v_perm_b32 v133, v62, v58, s14
v_perm_b32 v137, v63, v59, s13
v_perm_b32 v141, v63, v59, s14
s_waitcnt vmcnt(2)
v_perm_b32 v114, v68, v64, s13
v_perm_b32 v118, v68, v64, s14
v_perm_b32 v122, v69, v65, s13
v_perm_b32 v126, v69, v65, s14
v_perm_b32 v130, v70, v66, s13
v_perm_b32 v134, v70, v66, s14
v_perm_b32 v138, v71, v67, s13
v_perm_b32 v142, v71, v67, s14
s_waitcnt vmcnt(0)
v_perm_b32 v115, v76, v72, s13
v_perm_b32 v119, v76, v72, s14
v_perm_b32 v123, v77, v73, s13
v_perm_b32 v127, v77, v73, s14
v_perm_b32 v131, v78, v74, s13
v_perm_b32 v135, v78, v74, s14
v_perm_b32 v139, v79, v75, s13
v_perm_b32 v143, v79, v75, s14
s_branch L_v_m1
L_v_late:
s_waitcnt vmcnt(6)
v_perm_b32 v112, v52, v48, s13
v_perm_b32 v116, v52, v48, s14
v_perm_b32 v120, v53, v49, s13
v_perm_b32 v124, v53, v49, s14
v_perm_b32 v128, v54, v50, s13
v_perm_b32 v132, v54, v50, s14
v_perm_b32 v136, v55, v51, s13
v_perm_b32 v140, v55, v51, s14
s_waitcnt vmcnt(4)
v_perm_b32 v113, v60, v56, s13
v_perm_b32 v117, v60, v56, s14
v_perm_b32 v121, v61, v57, s13
v_perm_b32 v125, v61, v57, s14
v_perm_b32 v129, v62, v58, s13
v_perm_b32 v133, v62, v58, s14
v_perm_b32 v137, v63, v59, s13
v_perm_b32 v141, v63, v59, s14
s_waitcnt vmcnt(2)
v_perm_b32 v114, v68, v64, s13
v_perm_b32 v118, v68, v64, s14
v_perm_b32 v122, v69, v65, s13
v_perm_b32 v126, v69, v65, s14
v_perm_b32 v130, v70, v66, s13
v_perm_b32 v134, v70, v66, s14
v_perm_b32 v138, v71, v67, s13
v_perm_b32 v142, v71, v67, s14
s_waitcnt vmcnt(0)
v_perm_b32 v115, v76, v72, s13
v_perm_b32 v119, v76, v72, s14
v_perm_b32 v123, v77, v73, s13
v_perm_b32 v127, v77, v73, s14
v_perm_b32 v131, v78, v74, s13
v_perm_b32 v135, v78, v74, s14
v_perm_b32 v139, v79, v75, s13
v_perm_b32 v143, v79, v75, s14
s_mov_b32 s12, 0
L_lw_21:
ds_read_b32 v11, v4 offset:52
s_waitcnt lgkmcnt(0)
v_readfirstlane_b32 s8, v11
s_cmp_ge_u32 s8, 1
s_cbranch_scc1 L_lwd_22
s_add_u32 s12, s12, 1
s_cmp_lt_u32 s12, 2400000
s_cbranch_scc1 L_lw_21
L_lwd_22:
ds_read_b32 v12, v4 offset:8
ds_read_b128 v[144:147], v10 offset:4864
ds_read_b128 v[148:151], v10 offset:4992
s_waitcnt lgkmcnt(0)
v_readfirstlane_b32 s15, v12
v_mfma_f32_16x16x32_bf16 v[16:19], v[144:147], v[80:83], 0
v_mfma_f32_16x16x32_bf16 v[20:23], v[144:147], v[84:87], 0
v_mfma_f32_16x16x32_bf16 v[24:27], v[144:147], v[88:91], 0
v_mfma_f32_16x16x32_bf16 v[28:31], v[144:147], v[92:95], 0
v_mfma_f32_16x16x32_bf16 v[32:35], v[144:147], v[96:99], 0
v_mfma_f32_16x16x32_bf16 v[36:39], v[144:147], v[100:103], 0
v_mfma_f32_16x16x32_bf16 v[40:43], v[144:147], v[104:107], 0
v_mfma_f32_16x16x32_bf16 v[44:47], v[144:147], v[108:111], 0
L_v_m1:
s_nop 1
v_mfma_f32_16x16x32_bf16 v[16:19], v[148:151], v[112:115], v[16:19]
v_mfma_f32_16x16x32_bf16 v[20:23], v[148:151], v[116:119], v[20:23]
v_mfma_f32_16x16x32_bf16 v[24:27], v[148:151], v[120:123], v[24:27]
v_mfma_f32_16x16x32_bf16 v[28:31], v[148:151], v[124:127], v[28:31]
v_mfma_f32_16x16x32_bf16 v[32:35], v[148:151], v[128:131], v[32:35]
v_mfma_f32_16x16x32_bf16 v[36:39], v[148:151], v[132:135], v[36:39]
v_mfma_f32_16x16x32_bf16 v[40:43], v[148:151], v[136:139], v[40:43]
v_mfma_f32_16x16x32_bf16 v[44:47], v[148:151], v[140:143], v[44:47]
s_nop 3
v_add_f32_dpp v80, v18, v16 row_shl:8 row_mask:0xf bank_mask:0xf
v_add_f32_dpp v88, v19, v17 row_shl:8 row_mask:0xf bank_mask:0xf
v_add_f32_dpp v81, v22, v20 row_shl:8 row_mask:0xf bank_mask:0xf
v_add_f32_dpp v89, v23, v21 row_shl:8 row_mask:0xf bank_mask:0xf
v_add_f32_dpp v82, v26, v24 row_shl:8 row_mask:0xf bank_mask:0xf
v_add_f32_dpp v90, v27, v25 row_shl:8 row_mask:0xf bank_mask:0xf
v_add_f32_dpp v83, v30, v28 row_shl:8 row_mask:0xf bank_mask:0xf
v_add_f32_dpp v91, v31, v29 row_shl:8 row_mask:0xf bank_mask:0xf
v_add_f32_dpp v84, v34, v32 row_shl:8 row_mask:0xf bank_mask:0xf
v_add_f32_dpp v92, v35, v33 row_shl:8 row_mask:0xf bank_mask:0xf
v_add_f32_dpp v85, v38, v36 row_shl:8 row_mask:0xf bank_mask:0xf
v_add_f32_dpp v93, v39, v37 row_shl:8 row_mask:0xf bank_mask:0xf
v_add_f32_dpp v86, v42, v40 row_shl:8 row_mask:0xf bank_mask:0xf
v_add_f32_dpp v94, v43, v41 row_shl:8 row_mask:0xf bank_mask:0xf
s_nop 3
v_add_f32_dpp v87, v46, v44 row_shl:8 row_mask:0xf bank_mask:0xf
v_add_f32_dpp v95, v47, v45 row_shl:8 row_mask:0xf bank_mask:0xf
s_mov_b64 exec, 0xff
s_cmp_eq_u32 s15, 2
s_cbranch_scc1 L_v_ofast
s_mov_b64 exec, -1
s_mov_b32 s12, 0
L_lw_23:
ds_read_b32 v11, v4 offset:60
s_waitcnt lgkmcnt(0)
v_readfirstlane_b32 s8, v11
s_cmp_ge_u32 s8, 1
s_cbranch_scc1 L_lwd_24
s_sleep 1
s_add_u32 s12, s12, 1
s_cmp_lt_u32 s12, 2400000
s_cbranch_scc1 L_lw_23
L_lwd_24:
s_mov_b64 exec, 0xff
buffer_store_dwordx4 v[80:83], v9, s[52:55], s82 offen offset:0 sc1
buffer_store_dwordx4 v[84:87], v9, s[52:55], s82 offen offset:16 sc1
buffer_store_dwordx4 v[88:91], v9, s[52:55], s82 offen offset:1024 sc1
buffer_store_dwordx4 v[92:95], v9, s[52:55], s82 offen offset:1040 sc1
s_branch L_v_odone
L_v_ofast:
buffer_store_dwordx4 v[80:83], v9, s[52:55], s82 offen offset:0
buffer_store_dwordx4 v[84:87], v9, s[52:55], s82 offen offset:16
buffer_store_dwordx4 v[88:91], v9, s[52:55], s82 offen offset:1024
buffer_store_dwordx4 v[92:95], v9, s[52:55], s82 offen offset:1040
L_v_odone:
s_mov_b64 exec, -1
s_mov_b64 exec, 1
ds_add_u32 v4, v5 offset:44
s_mov_b64 exec, -1
s_endpgm
L_roleF:
s_lshr_b32 s8, s5, 3
s_lshl_b32 s8, s8, 3
s_add_u32 s80, s8, s4
s_and_b32 s81, s5, 7
s_mul_i32 s8, s5, 37
s_lshr_b32 s8, s8, 8
s_mul_i32 s9, s8, 7
s_sub_u32 s83, s5, s9
s_lshl_b32 s8, s8, 3
s_add_u32 s82, s8, s4
v_mov_b32 v4, 0
v_mov_b32 v5, 1
v_lshlrev_b32 v6, 4, v0
v_lshrrev_b32 v2, 3, v0
v_min_u32 v3, 6, v2
v_mul_u32_u24 v3, 28672, v3
v_and_b32 v7, 7, v0
v_lshl_add_u32 v3, v7, 4, v3
v_mul_u32_u24 v2, 7168, v2
v_lshl_add_u32 v2, v7, 4, v2
s_waitcnt lgkmcnt(0)
s_mov_b32 s52, s40
s_and_b32 s53, s41, 0xffff
s_mov_b32 s54, 134217728
s_mov_b32 s55, 0x20000
s_mov_b32 s44, s28
s_and_b32 s45, s29, 0xffff
s_mov_b32 s46, 1605632
s_mov_b32 s47, 0x20000
s_mov_b32 s48, s32
s_and_b32 s49, s33, 0xffff
s_mov_b32 s50, 1605632
s_mov_b32 s51, 0x20000
s_mov_b32 s56, s30
s_and_b32 s57, s31, 0xffff
s_mov_b32 s58, 3584
s_mov_b32 s59, 0x20000
s_add_u32 s8, s82, 32
s_lshl_b32 s8, s8, 11
s_lshl_b32 s9, s83, 8
s_add_u32 s8, s8, s9
s_add_u32 s84, s8, 1114112
s_setprio 1
s_mov_b32 s85, 0
s_cmp_ge_u32 s80, 28
s_cbranch_scc1 L_f_now1
s_mul_i32 s8, s81, 200704
s_lshl_b32 s9, s80, 7
s_add_u32 s8, s8, s9
s_add_u32 s9, s8, 0
buffer_load_dwordx4 v[16:19], v3, s[44:47], s9 offen nt
s_add_u32 s9, s8, 3584
buffer_load_dwordx4 v[20:23], v3, s[44:47], s9 offen nt
s_add_u32 s9, s8, 7168
buffer_load_dwordx4 v[24:27], v3, s[44:47], s9 offen nt
s_add_u32 s9, s8, 10752
buffer_load_dwordx4 v[28:31], v3, s[44:47], s9 offen nt
s_add_u32 s9, s8, 14336
buffer_load_dwordx4 v[32:35], v3, s[44:47], s9 offen nt
s_add_u32 s9, s8, 17920
buffer_load_dwordx4 v[36:39], v3, s[44:47], s9 offen nt
s_add_u32 s9, s8, 21504
buffer_load_dwordx4 v[40:43], v3, s[44:47], s9 offen nt
s_add_u32 s9, s8, 25088
buffer_load_dwordx4 v[44:47], v3, s[44:47], s9 offen nt
L_f_now1:
s_cmp_ge_u32 s82, 28
s_cbranch_scc1 L_f_noclr
v_mov_b32 v8, -1
v_mov_b32 v9, -1
v_mov_b32 v10, -1
v_mov_b32 v11, -1
s_mov_b64 exec, 0xffff
buffer_store_dwordx4 v[8:11], v6, s[52:55], s84 offen sc1
s_mov_b64 exec, -1
L_f_noclr:
s_cmp_ge_u32 s80, 28
s_cbranch_scc1 L_f_stage2
s_mov_b32 s12, 0
L_lw_25:
ds_read_b32 v11, v4 offset:16
s_waitcnt lgkmcnt(0)
v_readfirstlane_b32 s8, v11
s_cmp_ge_u32 s8, 1
s_cbranch_scc1 L_lwd_26
s_sleep 1
s_add_u32 s12, s12, 1
s_cmp_lt_u32 s12, 2400000
s_cbranch_scc1 L_lw_25
L_lwd_26:
v_bfe_u32 v12, v0, 1, 1
v_lshrrev_b32 v13, 4, v0
v_lshl_add_u32 v12, v13, 1, v12
v_cmp_gt_u32 vcc, 7, v12
v_lshlrev_b32 v12, 4, v12
s_mul_i32 s8, s81, 112
v_add_u32 v12, s8, v12
ds_read_b128 v[112:115], v12 offset:256
s_cmp_ge_u32 s82, 28
s_cbranch_scc1 L_f_w0
s_waitcnt vmcnt(1) lgkmcnt(0)
s_branch L_f_w1
L_f_w0:
s_waitcnt vmcnt(0) lgkmcnt(0)
L_f_w1:
v_cndmask_b32 v112, 0, v112, vcc
v_cndmask_b32 v113, 0, v113, vcc
v_cndmask_b32 v114, 0, v114, vcc
v_cndmask_b32 v115, 0, v115, vcc
v_perm_b32 v48, v20, v16, s13
v_perm_b32 v52, v20, v16, s14
v_perm_b32 v56, v21, v17, s13
v_perm_b32 v60, v21, v17, s14
v_perm_b32 v64, v22, v18, s13
v_perm_b32 v68, v22, v18, s14
v_perm_b32 v72, v23, v19, s13
v_perm_b32 v76, v23, v19, s14
v_perm_b32 v49, v28, v24, s13
v_perm_b32 v53, v28, v24, s14
v_perm_b32 v57, v29, v25, s13
v_perm_b32 v61, v29, v25, s14
v_perm_b32 v65, v30, v26, s13
v_perm_b32 v69, v30, v26, s14
v_perm_b32 v73, v31, v27, s13
v_perm_b32 v77, v31, v27, s14
v_perm_b32 v50, v36, v32, s13
v_perm_b32 v54, v36, v32, s14
v_perm_b32 v58, v37, v33, s13
v_perm_b32 v62, v37, v33, s14
v_perm_b32 v66, v38, v34, s13
v_perm_b32 v70, v38, v34, s14
v_perm_b32 v74, v39, v35, s13
v_perm_b32 v78, v39, v35, s14
v_perm_b32 v51, v44, v40, s13
v_perm_b32 v55, v44, v40, s14
v_perm_b32 v59, v45, v41, s13
v_perm_b32 v63, v45, v41, s14
v_perm_b32 v67, v46, v42, s13
v_perm_b32 v71, v46, v42, s14
v_perm_b32 v75, v47, v43, s13
v_perm_b32 v79, v47, v43, s14
s_nop 1
v_mfma_f32_16x16x32_bf16 v[80:83], v[112:115], v[48:51], 0
v_mfma_f32_16x16x32_bf16 v[84:87], v[112:115], v[52:55], 0
v_mfma_f32_16x16x32_bf16 v[88:91], v[112:115], v[56:59], 0
v_mfma_f32_16x16x32_bf16 v[92:95], v[112:115], v[60:63], 0
v_mfma_f32_16x16x32_bf16 v[96:99], v[112:115], v[64:67], 0
v_mfma_f32_16x16x32_bf16 v[100:103], v[112:115], v[68:71], 0
v_mfma_f32_16x16x32_bf16 v[104:107], v[112:115], v[72:75], 0
v_mfma_f32_16x16x32_bf16 v[108:111], v[112:115], v[76:79], 0
ds_read_b32 v9, v4 offset:72
s_waitcnt lgkmcnt(0)
s_mul_i32 s8, s80, 3072
s_mul_i32 s9, s81, 384
s_add_u32 s8, s8, s9
s_add_u32 s85, s8, 118784
s_nop 3
v_add_f32_dpp v116, v82, v80 row_shl:8 row_mask:0xf bank_mask:0xf
v_add_f32_dpp v117, v86, v84 row_shl:8 row_mask:0xf bank_mask:0xf
v_add_f32_dpp v118, v90, v88 row_shl:8 row_mask:0xf bank_mask:0xf
v_add_f32_dpp v120, v94, v92 row_shl:8 row_mask:0xf bank_mask:0xf
v_add_f32_dpp v121, v98, v96 row_shl:8 row_mask:0xf bank_mask:0xf
v_add_f32_dpp v122, v102, v100 row_shl:8 row_mask:0xf bank_mask:0xf
v_add_f32_dpp v124, v106, v104 row_shl:8 row_mask:0xf bank_mask:0xf
s_nop 3
v_add_f32_dpp v125, v110, v108 row_shl:8 row_mask:0xf bank_mask:0xf
v_mov_b32 v119, v9
v_mov_b32 v123, v9
v_mov_b32 v126, v9
v_mov_b32 v127, v9
s_mov_b64 exec, 0xff
buffer_store_dwordx4 v[116:119], v6, s[52:55], s85 offen offset:0
buffer_store_dwordx4 v[120:123], v6, s[52:55], s85 offen offset:128
buffer_store_dwordx4 v[124:127], v6, s[52:55], s85 offen offset:256
s_mov_b64 exec, -1
s_mov_b32 s86, s85
s_mov_b32 s87, 0
s_waitcnt vmcnt(0)
s_mov_b64 exec, 1
ds_add_u32 v4, v5 offset:20
s_mov_b64 exec, -1
s_branch L_f_stage2b
L_f_stage2:
s_mov_b32 s87, 1
s_waitcnt vmcnt(0) lgkmcnt(0)
s_mov_b64 exec, 1
ds_add_u32 v4, v5 offset:20
s_mov_b64 exec, -1
s_mov_b32 s12, 0
L_lw_27:
ds_read_b32 v11, v4 offset:16
s_waitcnt lgkmcnt(0)
v_readfirstlane_b32 s8, v11
s_cmp_ge_u32 s8, 1
s_cbranch_scc1 L_lwd_28
s_sleep 1
s_add_u32 s12, s12, 1
s_cmp_lt_u32 s12, 2400000
s_cbranch_scc1 L_lw_27
L_lwd_28:
ds_read_b32 v9, v4 offset:72
s_waitcnt lgkmcnt(0)
L_f_stage2b:
s_cmp_ge_u32 s82, 28
s_cbranch_scc1 L_f_endb
v_and_b32 v12, 7, v0
v_lshlrev_b32 v12, 4, v12
v_lshrrev_b32 v13, 3, v0
v_mul_u32_u24 v13, 384, v13
v_add_u32 v13, v13, v12
s_mul_i32 s8, s82, 3072
s_add_u32 s85, s8, 118784
v_mov_b32 v10, v9
s_mov_b32 s12, 0
L_lw_29:
ds_read_b32 v11, v4 offset:32
s_waitcnt lgkmcnt(0)
v_readfirstlane_b32 s8, v11
s_cmp_ge_u32 s8, 4
s_cbranch_scc1 L_lwd_30
s_sleep 1
s_add_u32 s12, s12, 1
s_cmp_lt_u32 s12, 2400000
s_cbranch_scc1 L_lw_29
L_lwd_30:
s_mov_b32 s12, 0
s_mov_b32 s88, 0
L_hpoll:
s_cmp_ge_u32 s88, 4
s_cselect_b32 s10, s88, 0
s_and_b32 s10, s10, 1
s_mul_i32 s10, s10, 262144
s_add_u32 s8, s10, s85
buffer_load_dwordx4 v[16:19], v13, s[52:55], s8 offen offset:0 sc1
buffer_load_dwordx4 v[20:23], v13, s[52:55], s8 offen offset:128 sc1
buffer_load_dwordx4 v[24:27], v13, s[52:55], s8 offen offset:256 sc1
s_waitcnt vmcnt(0)
L_h_chk:
v_xor_b32 v11, v19, v10
v_xor_b32 v28, v23, v10
v_or_b32 v11, v11, v28
v_xor_b32 v28, v27, v10
v_or_b32 v11, v11, v28
v_cmp_lt_u32 vcc, 7, v11
s_cmp_eq_u64 vcc, 0
s_cbranch_scc1 L_hgot
s_add_u32 s88, s88, 1
s_cmp_lg_u32 s88, 4
s_cbranch_scc1 L_h_nob
s_cmp_lg_u32 s87, 0
s_cbranch_scc1 L_fb_31
s_mov_b64 exec, 0xff
s_add_u32 s11, s86, 262144
buffer_store_dwordx4 v[116:119], v6, s[52:55], s11 offen offset:0 sc1
buffer_store_dwordx4 v[120:123], v6, s[52:55], s11 offen offset:128 sc1
buffer_store_dwordx4 v[124:127], v6, s[52:55], s11 offen offset:256 sc1
s_mov_b64 exec, -1
s_mov_b32 s87, 1
L_fb_31:
L_h_nob:
s_cmp_lt_u32 s88, 600000
s_cbranch_scc1 L_hpoll
L_hgot:
s_waitcnt vmcnt(0)
v_and_b32 v12, 7, v0
v_lshlrev_b32 v12, 4, v12
v_lshrrev_b32 v13, 4, v0
v_lshl_add_u32 v14, v13, 2, v12
s_lshl_b32 s8, s82, 7
v_add_u32 v15, s8, v14
buffer_load_dword v8, v15, s[56:59], 0 offen
s_mov_b32 s12, 0
L_lw_32:
ds_read_b32 v11, v4 offset:4
s_waitcnt lgkmcnt(0)
v_readfirstlane_b32 s8, v11
s_cmp_ge_u32 s8, 4
s_cbranch_scc1 L_lwd_33
s_sleep 1
s_add_u32 s12, s12, 1
s_cmp_lt_u32 s12, 2400000
s_cbranch_scc1 L_lw_32
L_lwd_33:
s_mul_i32 s8, s82, 57344
s_lshl_b32 s9, s83, 7
s_add_u32 s8, s8, s9
s_add_u32 s9, s8, 0
buffer_load_dwordx4 v[128:131], v2, s[48:51], s9 offen nt
s_add_u32 s9, s8, 896
buffer_load_dwordx4 v[132:135], v2, s[48:51], s9 offen nt
s_add_u32 s9, s8, 1792
buffer_load_dwordx4 v[136:139], v2, s[48:51], s9 offen nt
s_add_u32 s9, s8, 2688
buffer_load_dwordx4 v[140:143], v2, s[48:51], s9 offen nt
s_add_u32 s9, s8, 3584
buffer_load_dwordx4 v[144:147], v2, s[48:51], s9 offen nt
s_add_u32 s9, s8, 4480
buffer_load_dwordx4 v[148:151], v2, s[48:51], s9 offen nt
s_add_u32 s9, s8, 5376
buffer_load_dwordx4 v[152:155], v2, s[48:51], s9 offen nt
s_add_u32 s9, s8, 6272
buffer_load_dwordx4 v[156:159], v2, s[48:51], s9 offen nt
s_waitcnt vmcnt(8)
s_nop 1
v_add_f32_dpp v16, v16, v16 row_ror:8 row_mask:0xf bank_mask:0xf
v_add_f32_dpp v17, v17, v17 row_ror:8 row_mask:0xf bank_mask:0xf
v_add_f32_dpp v18, v18, v18 row_ror:8 row_mask:0xf bank_mask:0xf
v_add_f32_dpp v20, v20, v20 row_ror:8 row_mask:0xf bank_mask:0xf
v_add_f32_dpp v21, v21, v21 row_ror:8 row_mask:0xf bank_mask:0xf
v_add_f32_dpp v22, v22, v22 row_ror:8 row_mask:0xf bank_mask:0xf
v_add_f32_dpp v24, v24, v24 row_ror:8 row_mask:0xf bank_mask:0xf
v_add_f32_dpp v25, v25, v25 row_ror:8 row_mask:0xf bank_mask:0xf
s_nop 1
v_permlane32_swap_b32 v16, v21
v_permlane32_swap_b32 v17, v22
v_permlane32_swap_b32 v18, v24
v_permlane32_swap_b32 v20, v25
s_nop 1
v_add_f32 v16, v16, v21
v_add_f32 v17, v17, v22
v_add_f32 v18, v18, v24
v_add_f32 v20, v20, v25
s_nop 1
v_permlane16_swap_b32 v16, v18
v_permlane16_swap_b32 v17, v20
s_nop 1
v_add_f32 v16, v16, v18
v_add_f32 v17, v17, v20
v_cvt_pk_bf16_f32 v11, v16, v17
v_lshlrev_b32 v16, 16, v11
v_and_b32 v17, 0xffff0000, v11
v_lshlrev_b32 v11, 16, v8
v_and_b32 v12, 0xffff0000, v8
v_add_f32 v16, v16, v11
v_add_f32 v17, v17, v12
v_cvt_pk_bf16_f32 v11, v16, v17
v_lshlrev_b32 v16, 16, v11
v_and_b32 v17, 0xffff0000, v11
s_mov_b32 s10, 0x3d372713
s_mov_b32 s11, 0xc0135761
v_mul_f32 v60, v16, v16
v_mul_f32 v60, v60, v16
v_fma_f32 v60, v60, s10, v16
v_mul_f32 v60, s11, v60
v_exp_f32 v60, v60
s_nop 0
v_add_f32 v60, 1.0, v60
v_rcp_f32 v60, v60
s_nop 0
v_mul_f32 v16, v16, v60
v_mul_f32 v61, v17, v17
v_mul_f32 v61, v61, v17
v_fma_f32 v61, v61, s10, v17
v_mul_f32 v61, s11, v61
v_exp_f32 v61, v61
s_nop 0
v_add_f32 v61, 1.0, v61
v_rcp_f32 v61, v61
s_nop 0
v_mul_f32 v17, v17, v61
v_cvt_pk_bf16_f32 v11, v16, v17
ds_write_b32 v14, v11 offset:4608
v_bfe_u32 v12, v0, 1, 1
v_lshrrev_b32 v13, 4, v0
v_lshl_add_u32 v12, v13, 1, v12
v_lshlrev_b32 v12, 4, v12
ds_read_b128 v[112:115], v12 offset:4608
s_waitcnt vmcnt(0)
v_perm_b32 v48, v132, v128, s13
v_perm_b32 v52, v132, v128, s14
v_perm_b32 v56, v133, v129, s13
v_perm_b32 v60, v133, v129, s14
v_perm_b32 v64, v134, v130, s13
v_perm_b32 v68, v134, v130, s14
v_perm_b32 v72, v135, v131, s13
v_perm_b32 v76, v135, v131, s14
v_perm_b32 v49, v140, v136, s13
v_perm_b32 v53, v140, v136, s14
v_perm_b32 v57, v141, v137, s13
v_perm_b32 v61, v141, v137, s14
v_perm_b32 v65, v142, v138, s13
v_perm_b32 v69, v142, v138, s14
v_perm_b32 v73, v143, v139, s13
v_perm_b32 v77, v143, v139, s14
v_perm_b32 v50, v148, v144, s13
v_perm_b32 v54, v148, v144, s14
v_perm_b32 v58, v149, v145, s13
v_perm_b32 v62, v149, v145, s14
v_perm_b32 v66, v150, v146, s13
v_perm_b32 v70, v150, v146, s14
v_perm_b32 v74, v151, v147, s13
v_perm_b32 v78, v151, v147, s14
v_perm_b32 v51, v156, v152, s13
v_perm_b32 v55, v156, v152, s14
v_perm_b32 v59, v157, v153, s13
v_perm_b32 v63, v157, v153, s14
v_perm_b32 v67, v158, v154, s13
v_perm_b32 v71, v158, v154, s14
v_perm_b32 v75, v159, v155, s13
v_perm_b32 v79, v159, v155, s14
s_waitcnt lgkmcnt(0)
v_mfma_f32_16x16x32_bf16 v[80:83], v[112:115], v[48:51], 0
v_mfma_f32_16x16x32_bf16 v[84:87], v[112:115], v[52:55], 0
v_mfma_f32_16x16x32_bf16 v[88:91], v[112:115], v[56:59], 0
v_mfma_f32_16x16x32_bf16 v[92:95], v[112:115], v[60:63], 0
v_mfma_f32_16x16x32_bf16 v[96:99], v[112:115], v[64:67], 0
v_mfma_f32_16x16x32_bf16 v[100:103], v[112:115], v[68:71], 0
v_mfma_f32_16x16x32_bf16 v[104:107], v[112:115], v[72:75], 0
v_mfma_f32_16x16x32_bf16 v[108:111], v[112:115], v[76:79], 0
v_and_b32 v10, 7, v0
v_lshlrev_b32 v10, 5, v10
s_nop 3
v_add_f32_dpp v16, v82, v80 row_shl:8 row_mask:0xf bank_mask:0xf
v_add_f32_dpp v17, v86, v84 row_shl:8 row_mask:0xf bank_mask:0xf
v_add_f32_dpp v18, v90, v88 row_shl:8 row_mask:0xf bank_mask:0xf
v_add_f32_dpp v19, v94, v92 row_shl:8 row_mask:0xf bank_mask:0xf
v_add_f32_dpp v20, v98, v96 row_shl:8 row_mask:0xf bank_mask:0xf
v_add_f32_dpp v21, v102, v100 row_shl:8 row_mask:0xf bank_mask:0xf
v_add_f32_dpp v22, v106, v104 row_shl:8 row_mask:0xf bank_mask:0xf
s_nop 3
v_add_f32_dpp v23, v110, v108 row_shl:8 row_mask:0xf bank_mask:0xf
s_mov_b64 exec, 0xff
buffer_store_dwordx4 v[16:19], v10, s[52:55], s84 offen sc1
buffer_store_dwordx4 v[20:23], v10, s[52:55], s84 offen offset:16 sc1
s_mov_b64 exec, -1
L_f_endb:
s_cmp_lg_u32 s87, 0
s_cbranch_scc1 L_fb_34
s_mov_b64 exec, 0xff
s_add_u32 s11, s86, 262144
buffer_store_dwordx4 v[116:119], v6, s[52:55], s11 offen offset:0 sc1
buffer_store_dwordx4 v[120:123], v6, s[52:55], s11 offen offset:128 sc1
buffer_store_dwordx4 v[124:127], v6, s[52:55], s11 offen offset:256 sc1
s_mov_b64 exec, -1
s_mov_b32 s87, 1
L_fb_34:
L_f_end:
s_endpgm
L_roleW:
s_setprio 2
v_mov_b32 v4, 0
v_mov_b32 v5, 1
v_lshlrev_b32 v6, 4, v0
s_and_b32 s80, s5, 3
s_lshr_b32 s81, s5, 2
s_lshl_b32 s8, s4, 2
s_add_u32 s8, s8, s80
s_mul_i32 s83, s8, 114688
s_lshl_b32 s9, s81, 7
s_add_u32 s83, s83, s9
s_lshl_b32 s8, s4, 25
s_lshl_b32 s9, s5, 16
s_add_u32 s8, s8, s9
s_add_u32 s8, s8, 0x1E00000
s_mov_b32 s84, s8
s_waitcnt lgkmcnt(0)
s_mov_b32 s52, s40
s_and_b32 s53, s41, 0xffff
s_mov_b32 s54, 134217728
s_mov_b32 s55, 0x20000
s_mov_b32 s12, 0
L_lw_35:
ds_read_b32 v11, v4 offset:56
s_waitcnt lgkmcnt(0)
v_readfirstlane_b32 s8, v11
s_cmp_ge_u32 s8, 1
s_cbranch_scc1 L_lwd_36
s_add_u32 s12, s12, 1
s_cmp_lt_u32 s12, 2400000
s_cbranch_scc1 L_lw_35
L_lwd_36:
v_mov_b32 v8, -1
v_mov_b32 v9, -1
v_mov_b32 v10, -1
v_mov_b32 v11, -1
s_lshl_b32 s8, s4, 5
s_add_u32 s8, s8, s5
s_lshl_b32 s8, s8, 11
s_add_u32 s8, s8, 589824
buffer_store_dwordx4 v[8:11], v6, s[52:55], s8 offen
buffer_store_dwordx4 v[8:11], v6, s[52:55], s8 offen offset:1024
v_lshlrev_b32 v7, 8, v0
s_lshl_b32 s8, s4, 9
s_lshl_b32 s9, s5, 3
s_add_u32 s8, s8, s9
s_add_u32 s8, s8, 8192
s_mov_b64 exec, 3
buffer_store_dwordx2 v[8:9], v7, s[52:55], s8 offen
s_mov_b64 exec, -1
s_lshl_b32 s8, s4, 2
s_add_u32 s8, s8, s80
s_lshl_b32 s8, s8, 11
s_lshl_b32 s9, s81, 8
s_add_u32 s8, s8, s9
s_add_u32 s82, s8, 1114112
s_cmp_ge_u32 s5, 28
s_cbranch_scc1 L_w_noap
s_mov_b64 exec, 0xffff
buffer_store_dwordx4 v[8:11], v6, s[52:55], s82 offen sc1
s_mov_b64 exec, -1
L_w_noap:
s_load_dword s7, s[40:41], 0
s_waitcnt vmcnt(0) lgkmcnt(0)
s_add_u32 s7, s7, 8
s_andn2_b32 s7, s7, 7
v_mov_b32 v7, s7
s_mov_b32 s12, 0
L_lw_37:
ds_read_b32 v11, v4 offset:20
s_waitcnt lgkmcnt(0)
v_readfirstlane_b32 s8, v11
s_cmp_ge_u32 s8, 1
s_cbranch_scc1 L_lwd_38
s_sleep 1
s_add_u32 s12, s12, 1
s_cmp_lt_u32 s12, 2400000
s_cbranch_scc1 L_lw_37
L_lwd_38:
s_mov_b32 s12, 0
L_lw_39:
ds_read_b32 v11, v4 offset:16
s_waitcnt lgkmcnt(0)
v_readfirstlane_b32 s8, v11
s_cmp_ge_u32 s8, 1
s_cbranch_scc1 L_lwd_40
s_sleep 1
s_add_u32 s12, s12, 1
s_cmp_lt_u32 s12, 2400000
s_cbranch_scc1 L_lw_39
L_lwd_40:
s_lshl_b32 s8, s4, 5
s_add_u32 s8, s8, s5
s_lshl_b32 s8, s8, 2
s_add_u32 s8, s8, 4096
s_mov_b64 exec, 1
buffer_store_dword v7, v4, s[52:55], s8 offen sc1
s_mov_b64 exec, -1
s_mov_b32 s85, s8
s_mov_b32 s12, 0
L_lw_41:
ds_read_b32 v11, v4 offset:8
s_waitcnt lgkmcnt(0)
v_readfirstlane_b32 s8, v11
s_cmp_ge_u32 s8, 1
s_cbranch_scc1 L_lwd_42
s_sleep 1
s_add_u32 s12, s12, 1
s_cmp_lt_u32 s12, 2400000
s_cbranch_scc1 L_lw_41
L_lwd_42:
s_cmp_eq_u32 s8, 2
s_cbranch_scc1 L_w_fastmode
v_mov_b32 v8, -1
v_mov_b32 v9, -1
v_mov_b32 v10, -1
v_mov_b32 v11, -1
s_lshl_b32 s8, s4, 5
s_add_u32 s8, s8, s5
s_lshl_b32 s8, s8, 11
s_add_u32 s8, s8, 589824
buffer_store_dwordx4 v[8:11], v6, s[52:55], s8 offen sc1
buffer_store_dwordx4 v[8:11], v6, s[52:55], s8 offen offset:1024 sc1
v_lshlrev_b32 v12, 8, v0
s_lshl_b32 s8, s4, 9
s_lshl_b32 s9, s5, 3
s_add_u32 s8, s8, s9
s_add_u32 s8, s8, 8192
s_mov_b64 exec, 3
buffer_store_dwordx2 v[8:9], v12, s[52:55], s8 offen sc1
s_mov_b64 exec, 1
s_waitcnt vmcnt(0)
v_or_b32 v12, 1, v7
buffer_store_dword v12, v4, s[52:55], s85 offen sc1
s_mov_b64 exec, -1
s_mov_b64 exec, 1
ds_add_u32 v4, v5 offset:60
s_mov_b64 exec, -1
L_w_fastmode:
s_cmp_ge_u32 s5, 28
s_cbranch_scc1 L_final
s_mov_b32 s44, s24
s_and_b32 s45, s25, 0xffff
s_mov_b32 s46, 3670016
s_mov_b32 s47, 0x20000
v_lshrrev_b32 v2, 3, v0
v_mul_u32_u24 v2, 7168, v2
v_and_b32 v3, 7, v0
v_lshl_add_u32 v2, v3, 4, v2
v_bfe_u32 v10, v0, 1, 1
v_lshrrev_b32 v11, 4, v0
v_lshl_add_u32 v10, v11, 1, v10
v_lshlrev_b32 v10, 4, v10
v_lshlrev_b32 v9, 5, v3
s_add_u32 s16, s83, 0
s_add_u32 s17, s83, 896
s_add_u32 s18, s83, 1792
s_add_u32 s19, s83, 2688
s_add_u32 s20, s83, 3584
s_add_u32 s21, s83, 4480
s_add_u32 s22, s83, 5376
s_add_u32 s23, s83, 6272
s_add_u32 s24, s83, 57344
s_add_u32 s25, s83, 58240
s_add_u32 s26, s83, 59136
s_add_u32 s27, s83, 60032
s_add_u32 s28, s83, 60928
s_add_u32 s29, s83, 61824
s_add_u32 s30, s83, 62720
s_add_u32 s31, s83, 63616
s_mov_b32 s12, 0
L_lw_43:
ds_read_b32 v11, v4 offset:4
s_waitcnt lgkmcnt(0)
v_readfirstlane_b32 s8, v11
s_cmp_ge_u32 s8, 4
s_cbranch_scc1 L_lwd_44
s_sleep 1
s_add_u32 s12, s12, 1
s_cmp_lt_u32 s12, 2400000
s_cbranch_scc1 L_lw_43
L_lwd_44:
buffer_load_dwordx4 v[16:19], v2, s[44:47], s16 offen nt
buffer_load_dwordx4 v[20:23], v2, s[44:47], s17 offen nt
buffer_load_dwordx4 v[24:27], v2, s[44:47], s18 offen nt
buffer_load_dwordx4 v[28:31], v2, s[44:47], s19 offen nt
buffer_load_dwordx4 v[32:35], v2, s[44:47], s20 offen nt
buffer_load_dwordx4 v[36:39], v2, s[44:47], s21 offen nt
buffer_load_dwordx4 v[40:43], v2, s[44:47], s22 offen nt
buffer_load_dwordx4 v[44:47], v2, s[44:47], s23 offen nt
s_waitcnt vmcnt(7)
buffer_load_dwordx4 v[48:51], v2, s[44:47], s24 offen nt
s_waitcnt vmcnt(7)
buffer_load_dwordx4 v[52:55], v2, s[44:47], s25 offen nt
s_waitcnt vmcnt(7)
buffer_load_dwordx4 v[56:59], v2, s[44:47], s26 offen nt
s_waitcnt vmcnt(7)
buffer_load_dwordx4 v[60:63], v2, s[44:47], s27 offen nt
s_waitcnt vmcnt(7)
buffer_load_dwordx4 v[64:67], v2, s[44:47], s28 offen nt
s_waitcnt vmcnt(7)
buffer_load_dwordx4 v[68:71], v2, s[44:47], s29 offen nt
s_waitcnt vmcnt(7)
buffer_load_dwordx4 v[72:75], v2, s[44:47], s30 offen nt
s_waitcnt vmcnt(7)
buffer_load_dwordx4 v[76:79], v2, s[44:47], s31 offen nt
L_w_issued:
s_mov_b64 exec, 1
ds_add_u32 v4, v5 offset:64
s_mov_b64 exec, -1
s_waitcnt vmcnt(8)
v_perm_b32 v80, v20, v16, s13
v_perm_b32 v84, v20, v16, s14
v_perm_b32 v88, v21, v17, s13
v_perm_b32 v92, v21, v17, s14
v_perm_b32 v96, v22, v18, s13
v_perm_b32 v100, v22, v18, s14
v_perm_b32 v104, v23, v19, s13
v_perm_b32 v108, v23, v19, s14
v_perm_b32 v81, v28, v24, s13
v_perm_b32 v85, v28, v24, s14
v_perm_b32 v89, v29, v25, s13
v_perm_b32 v93, v29, v25, s14
v_perm_b32 v97, v30, v26, s13
v_perm_b32 v101, v30, v26, s14
v_perm_b32 v105, v31, v27, s13
v_perm_b32 v109, v31, v27, s14
v_perm_b32 v82, v36, v32, s13
v_perm_b32 v86, v36, v32, s14
v_perm_b32 v90, v37, v33, s13
v_perm_b32 v94, v37, v33, s14
v_perm_b32 v98, v38, v34, s13
v_perm_b32 v102, v38, v34, s14
v_perm_b32 v106, v39, v35, s13
v_perm_b32 v110, v39, v35, s14
v_perm_b32 v83, v44, v40, s13
v_perm_b32 v87, v44, v40, s14
v_perm_b32 v91, v45, v41, s13
v_perm_b32 v95, v45, v41, s14
v_perm_b32 v99, v46, v42, s13
v_perm_b32 v103, v46, v42, s14
v_perm_b32 v107, v47, v43, s13
v_perm_b32 v111, v47, v43, s14
s_waitcnt vmcnt(0)
v_perm_b32 v112, v52, v48, s13
v_perm_b32 v116, v52, v48, s14
v_perm_b32 v120, v53, v49, s13
v_perm_b32 v124, v53, v49, s14
v_perm_b32 v128, v54, v50, s13
v_perm_b32 v132, v54, v50, s14
v_perm_b32 v136, v55, v51, s13
v_perm_b32 v140, v55, v51, s14
v_perm_b32 v113, v60, v56, s13
v_perm_b32 v117, v60, v56, s14
v_perm_b32 v121, v61, v57, s13
v_perm_b32 v125, v61, v57, s14
v_perm_b32 v129, v62, v58, s13
v_perm_b32 v133, v62, v58, s14
v_perm_b32 v137, v63, v59, s13
v_perm_b32 v141, v63, v59, s14
v_perm_b32 v114, v68, v64, s13
v_perm_b32 v118, v68, v64, s14
v_perm_b32 v122, v69, v65, s13
v_perm_b32 v126, v69, v65, s14
v_perm_b32 v130, v70, v66, s13
v_perm_b32 v134, v70, v66, s14
v_perm_b32 v138, v71, v67, s13
v_perm_b32 v142, v71, v67, s14
v_perm_b32 v115, v76, v72, s13
v_perm_b32 v119, v76, v72, s14
v_perm_b32 v123, v77, v73, s13
v_perm_b32 v127, v77, v73, s14
v_perm_b32 v131, v78, v74, s13
v_perm_b32 v135, v78, v74, s14
v_perm_b32 v139, v79, v75, s13
v_perm_b32 v143, v79, v75, s14
s_mov_b32 s12, 0
L_lw_45:
ds_read_b32 v11, v4 offset:24
s_waitcnt lgkmcnt(0)
v_readfirstlane_b32 s8, v11
s_cmp_ge_u32 s8, 4
s_cbranch_scc1 L_lwd_46
s_add_u32 s12, s12, 1
s_cmp_lt_u32 s12, 2400000
s_cbranch_scc1 L_lw_45
L_lwd_46:
ds_read_b128 v[16:19], v10 offset:4352
ds_read_b128 v[20:23], v10 offset:4480
s_waitcnt lgkmcnt(0)
v_mfma_f32_16x16x32_bf16 v[32:35], v[16:19], v[80:83], 0
v_mfma_f32_16x16x32_bf16 v[36:39], v[16:19], v[84:87], 0
v_mfma_f32_16x16x32_bf16 v[40:43], v[16:19], v[88:91], 0
v_mfma_f32_16x16x32_bf16 v[44:47], v[16:19], v[92:95], 0
v_mfma_f32_16x16x32_bf16 v[48:51], v[16:19], v[96:99], 0
v_mfma_f32_16x16x32_bf16 v[52:55], v[16:19], v[100:103], 0
v_mfma_f32_16x16x32_bf16 v[56:59], v[16:19], v[104:107], 0
v_mfma_f32_16x16x32_bf16 v[60:63], v[16:19], v[108:111], 0
v_mfma_f32_16x16x32_bf16 v[32:35], v[20:23], v[112:115], v[32:35]
v_mfma_f32_16x16x32_bf16 v[36:39], v[20:23], v[116:119], v[36:39]
v_mfma_f32_16x16x32_bf16 v[40:43], v[20:23], v[120:123], v[40:43]
v_mfma_f32_16x16x32_bf16 v[44:47], v[20:23], v[124:127], v[44:47]
v_mfma_f32_16x16x32_bf16 v[48:51], v[20:23], v[128:131], v[48:51]
v_mfma_f32_16x16x32_bf16 v[52:55], v[20:23], v[132:135], v[52:55]
v_mfma_f32_16x16x32_bf16 v[56:59], v[20:23], v[136:139], v[56:59]
v_mfma_f32_16x16x32_bf16 v[60:63], v[20:23], v[140:143], v[60:63]
s_nop 3
v_add_f32_dpp v64, v34, v32 row_shl:8 row_mask:0xf bank_mask:0xf
v_add_f32_dpp v65, v38, v36 row_shl:8 row_mask:0xf bank_mask:0xf
v_add_f32_dpp v66, v42, v40 row_shl:8 row_mask:0xf bank_mask:0xf
v_add_f32_dpp v67, v46, v44 row_shl:8 row_mask:0xf bank_mask:0xf
v_add_f32_dpp v68, v50, v48 row_shl:8 row_mask:0xf bank_mask:0xf
v_add_f32_dpp v69, v54, v52 row_shl:8 row_mask:0xf bank_mask:0xf
v_add_f32_dpp v70, v58, v56 row_shl:8 row_mask:0xf bank_mask:0xf
s_nop 3
v_add_f32_dpp v71, v62, v60 row_shl:8 row_mask:0xf bank_mask:0xf
s_mov_b64 exec, 0xff
buffer_store_dwordx4 v[64:67], v9, s[52:55], s82 offen sc1
buffer_store_dwordx4 v[68:71], v9, s[52:55], s82 offen offset:16 sc1
s_mov_b64 exec, -1
s_endpgm
L_final:
s_sub_u32 s8, s5, 28
s_lshl_b32 s8, s8, 3
s_add_u32 s80, s8, s4
s_cmp_ge_u32 s80, 28
s_cbranch_scc1 L_end
s_mov_b32 s44, s16
s_and_b32 s45, s17, 0xffff
s_mov_b32 s46, 896
s_mov_b32 s47, 0x20000
s_mov_b32 s48, s34
s_and_b32 s49, s35, 0xffff
s_mov_b32 s50, 896
s_mov_b32 s51, 0x20000
s_mov_b32 s56, s36
s_and_b32 s57, s37, 0xffff
s_mov_b32 s58, 896
s_mov_b32 s59, 0x20000
v_and_b32 v2, 3, v0
v_lshlrev_b32 v2, 2, v2
v_bfe_u32 v3, v0, 5, 1
v_lshl_add_u32 v2, v3, 1, v2
v_bfe_u32 v3, v0, 4, 1
v_add_u32 v2, v2, v3
s_lshl_b32 s8, s80, 4
v_add_u32 v2, s8, v2
v_lshlrev_b32 v2, 1, v2
buffer_load_ushort v12, v2, s[44:47], 0 offen
buffer_load_ushort v13, v2, s[48:51], 0 offen
s_mov_b32 s9, 4096
s_mov_b32 s12, 0
L_lw_47:
ds_read_b32 v11, v4 offset:0
s_waitcnt lgkmcnt(0)
v_readfirstlane_b32 s8, v11
s_cmp_ge_u32 s8, 4
s_cbranch_scc1 L_lwd_48
s_sleep 1
s_add_u32 s12, s12, 1
s_cmp_lt_u32 s12, 2400000
s_cbranch_scc1 L_lw_47
L_lwd_48:
s_mov_b32 s12, 0
L_rdy:
buffer_load_dwordx4 v[8:11], v6, s[52:55], s9 offen sc1
s_waitcnt vmcnt(0)
v_xor_b32 v8, v8, v7
v_xor_b32 v9, v9, v7
v_xor_b32 v10, v10, v7
v_xor_b32 v11, v11, v7
v_or_b32 v8, v8, v9
v_or_b32 v10, v10, v11
v_or_b32 v8, v8, v10
v_cmp_lt_u32 vcc, 7, v8
s_cmp_eq_u64 vcc, 0
s_cbranch_scc1 L_rdy_ok
s_sleep 8
s_add_u32 s12, s12, 1
s_cmp_lt_u32 s12, 600000
s_cbranch_scc1 L_rdy
L_rdy_ok:
s_cmp_lg_u32 s80, 0
s_cbranch_scc1 L_noep
s_mov_b64 exec, 1
buffer_store_dword v7, v4, s[52:55], 0 offen sc1
s_mov_b64 exec, -1
L_noep:
v_lshrrev_b32 v3, 2, v0
v_lshlrev_b32 v3, 11, v3
v_and_b32 v7, 3, v0
v_lshl_add_u32 v3, v7, 4, v3
s_lshl_b32 s81, s80, 6
s_add_u32 s81, s81, 1114112
v_lshlrev_b32 v13, 16, v13
v_lshlrev_b32 v12, 16, v12
v_lshrrev_b32 v14, 2, v0
v_min_u32 v14, 11, v14
v_lshlrev_b32 v14, 11, v14
v_lshl_add_u32 v14, v7, 4, v14
v_cmp_gt_u32 vcc, 48, v0
s_nop 1
v_cndmask_b32 v15, 0, 1.0, vcc
s_mov_b32 s12, 0
L_lw_49:
ds_read_b32 v11, v4 offset:4
s_waitcnt lgkmcnt(0)
v_readfirstlane_b32 s8, v11
s_cmp_ge_u32 s8, 4
s_cbranch_scc1 L_lwd_50
s_sleep 1
s_add_u32 s12, s12, 1
s_cmp_lt_u32 s12, 2400000
s_cbranch_scc1 L_lw_49
L_lwd_50:
s_mov_b32 s12, 0
L_lw_51:
ds_read_b32 v11, v4 offset:12
s_waitcnt lgkmcnt(0)
v_readfirstlane_b32 s8, v11
s_cmp_ge_u32 s8, 4
s_cbranch_scc1 L_lwd_52
s_sleep 1
s_add_u32 s12, s12, 1
s_cmp_lt_u32 s12, 2400000
s_cbranch_scc1 L_lw_51
L_lwd_52:
s_mov_b32 s12, 0
L_bpoll:
s_add_u32 s9, s81, 65536
buffer_load_dwordx4 v[24:27], v3, s[52:55], s9 offen sc1
s_add_u32 s9, s81, 98304
buffer_load_dwordx4 v[28:31], v14, s[52:55], s9 offen sc1
s_waitcnt vmcnt(0)
v_fma_f32 v104, v28, v15, v24
v_fma_f32 v105, v29, v15, v25
v_fma_f32 v106, v30, v15, v26
v_fma_f32 v107, v31, v15, v27
v_add_f32 v16, v104, v105
v_add_f32 v16, v16, v106
v_add_f32 v16, v16, v107
v_cmp_u_f32 vcc, v16, v16
s_cmp_eq_u64 vcc, 0
s_cbranch_scc1 L_bgot
v_max_u32 v16, v24, v25
v_max3_u32 v16, v16, v26, v27
v_max3_u32 v16, v16, v28, v29
v_max3_u32 v16, v16, v30, v31
v_cmp_eq_u32 vcc, -1, v16
s_cmp_eq_u64 vcc, 0
s_cbranch_scc1 L_bgot
s_add_u32 s12, s12, 1
s_cmp_lt_u32 s12, 600000
s_cbranch_scc1 L_bpoll
L_bgot:
s_nop 1
v_add_f32_dpp v104, v104, v104 row_ror:4 row_mask:0xf bank_mask:0xf
v_add_f32_dpp v105, v105, v105 row_ror:4 row_mask:0xf bank_mask:0xf
v_add_f32_dpp v106, v106, v106 row_ror:4 row_mask:0xf bank_mask:0xf
v_add_f32_dpp v107, v107, v107 row_ror:4 row_mask:0xf bank_mask:0xf
s_nop 1
v_add_f32_dpp v104, v104, v104 row_ror:8 row_mask:0xf bank_mask:0xf
v_add_f32_dpp v105, v105, v105 row_ror:8 row_mask:0xf bank_mask:0xf
v_add_f32_dpp v106, v106, v106 row_ror:8 row_mask:0xf bank_mask:0xf
v_add_f32_dpp v107, v107, v107 row_ror:8 row_mask:0xf bank_mask:0xf
s_nop 1
v_permlane32_swap_b32 v104, v106
v_permlane32_swap_b32 v105, v107
s_nop 1
v_add_f32 v104, v104, v106
v_add_f32 v105, v105, v107
s_nop 1
v_permlane16_swap_b32 v104, v105
s_nop 1
v_add_f32 v104, v104, v105
v_cvt_pk_bf16_f32 v104, v104, v104
v_lshlrev_b32 v104, 16, v104
v_add_f32 v104, v104, v13
v_cvt_pk_bf16_f32 v104, v104, v104
v_lshlrev_b32 v104, 16, v104
s_add_u32 s82, s81, 32768
s_mov_b32 s12, 0
buffer_load_dwordx4 v[32:35], v3, s[52:55], s81 offen sc1
buffer_load_dwordx4 v[36:39], v3, s[52:55], s82 offen sc1
s_sleep 1
buffer_load_dwordx4 v[40:43], v3, s[52:55], s81 offen sc1
buffer_load_dwordx4 v[44:47], v3, s[52:55], s82 offen sc1
s_sleep 1
buffer_load_dwordx4 v[48:51], v3, s[52:55], s81 offen sc1
buffer_load_dwordx4 v[52:55], v3, s[52:55], s82 offen sc1
s_sleep 1
buffer_load_dwordx4 v[56:59], v3, s[52:55], s81 offen sc1
buffer_load_dwordx4 v[60:63], v3, s[52:55], s82 offen sc1
L_fpoll:
s_waitcnt vmcnt(6)
v_add_f32 v100, v32, v36
v_add_f32 v101, v33, v37
v_add_f32 v102, v34, v38
v_add_f32 v103, v35, v39
v_add_f32 v16, v100, v101
v_add_f32 v17, v102, v103
v_add_f32 v16, v16, v17
v_cmp_u_f32 vcc, v16, v16
s_cmp_eq_u64 vcc, 0
s_cbranch_scc1 L_fgot
v_max3_u32 v16, v32, v33, v34
v_max3_u32 v16, v16, v35, v36
v_max3_u32 v16, v16, v37, v38
v_max_u32 v16, v16, v39
v_cmp_eq_u32 vcc, -1, v16
s_cmp_eq_u64 vcc, 0
s_cbranch_scc1 L_fgot
buffer_load_dwordx4 v[32:35], v3, s[52:55], s81 offen sc1
buffer_load_dwordx4 v[36:39], v3, s[52:55], s82 offen sc1
s_waitcnt vmcnt(6)
v_add_f32 v100, v40, v44
v_add_f32 v101, v41, v45
v_add_f32 v102, v42, v46
v_add_f32 v103, v43, v47
v_add_f32 v16, v100, v101
v_add_f32 v17, v102, v103
v_add_f32 v16, v16, v17
v_cmp_u_f32 vcc, v16, v16
s_cmp_eq_u64 vcc, 0
s_cbranch_scc1 L_fgot
v_max3_u32 v16, v40, v41, v42
v_max3_u32 v16, v16, v43, v44
v_max3_u32 v16, v16, v45, v46
v_max_u32 v16, v16, v47
v_cmp_eq_u32 vcc, -1, v16
s_cmp_eq_u64 vcc, 0
s_cbranch_scc1 L_fgot
buffer_load_dwordx4 v[40:43], v3, s[52:55], s81 offen sc1
buffer_load_dwordx4 v[44:47], v3, s[52:55], s82 offen sc1
s_waitcnt vmcnt(6)
v_add_f32 v100, v48, v52
v_add_f32 v101, v49, v53
v_add_f32 v102, v50, v54
v_add_f32 v103, v51, v55
v_add_f32 v16, v100, v101
v_add_f32 v17, v102, v103
v_add_f32 v16, v16, v17
v_cmp_u_f32 vcc, v16, v16
s_cmp_eq_u64 vcc, 0
s_cbranch_scc1 L_fgot
v_max3_u32 v16, v48, v49, v50
v_max3_u32 v16, v16, v51, v52
v_max3_u32 v16, v16, v53, v54
v_max_u32 v16, v16, v55
v_cmp_eq_u32 vcc, -1, v16
s_cmp_eq_u64 vcc, 0
s_cbranch_scc1 L_fgot
buffer_load_dwordx4 v[48:51], v3, s[52:55], s81 offen sc1
buffer_load_dwordx4 v[52:55], v3, s[52:55], s82 offen sc1
s_waitcnt vmcnt(6)
v_add_f32 v100, v56, v60
v_add_f32 v101, v57, v61
v_add_f32 v102, v58, v62
v_add_f32 v103, v59, v63
v_add_f32 v16, v100, v101
v_add_f32 v17, v102, v103
v_add_f32 v16, v16, v17
v_cmp_u_f32 vcc, v16, v16
s_cmp_eq_u64 vcc, 0
s_cbranch_scc1 L_fgot
v_max3_u32 v16, v56, v57, v58
v_max3_u32 v16, v16, v59, v60
v_max3_u32 v16, v16, v61, v62
v_max_u32 v16, v16, v63
v_cmp_eq_u32 vcc, -1, v16
s_cmp_eq_u64 vcc, 0
s_cbranch_scc1 L_fgot
buffer_load_dwordx4 v[56:59], v3, s[52:55], s81 offen sc1
buffer_load_dwordx4 v[60:63], v3, s[52:55], s82 offen sc1
s_add_u32 s12, s12, 1
s_cmp_lt_u32 s12, 600000
s_cbranch_scc1 L_fpoll
L_fgot:
s_nop 1
v_add_f32_dpp v100, v100, v100 row_ror:4 row_mask:0xf bank_mask:0xf
v_add_f32_dpp v101, v101, v101 row_ror:4 row_mask:0xf bank_mask:0xf
v_add_f32_dpp v102, v102, v102 row_ror:4 row_mask:0xf bank_mask:0xf
v_add_f32_dpp v103, v103, v103 row_ror:4 row_mask:0xf bank_mask:0xf
s_nop 1
v_add_f32_dpp v100, v100, v100 row_ror:8 row_mask:0xf bank_mask:0xf
v_add_f32_dpp v101, v101, v101 row_ror:8 row_mask:0xf bank_mask:0xf
v_add_f32_dpp v102, v102, v102 row_ror:8 row_mask:0xf bank_mask:0xf
v_add_f32_dpp v103, v103, v103 row_ror:8 row_mask:0xf bank_mask:0xf
s_nop 1
v_permlane32_swap_b32 v100, v102
v_permlane32_swap_b32 v101, v103
s_nop 1
v_add_f32 v100, v100, v102
v_add_f32 v101, v101, v103
s_nop 1
v_permlane16_swap_b32 v100, v101
s_nop 1
v_add_f32 v100, v100, v101
v_cvt_pk_bf16_f32 v100, v100, v100
v_lshlrev_b32 v100, 16, v100
v_add_f32 v100, v100, v12
v_cvt_pk_bf16_f32 v100, v100, v100
v_lshlrev_b32 v100, 16, v100
v_add_f32 v100, v100, v104
v_cvt_pk_bf16_f32 v100, v100, v100
s_mov_b32 exec_lo, 0x000f000f
s_mov_b32 exec_hi, 0x000f000f
buffer_store_short v100, v2, s[56:59], 0 offen
s_mov_b64 exec, -1
L_end:
s_endpgm
L_code_end:
.section .rodata,"a"
.p2align 6
.amdhsa_kernel parallel_sum__sliding_block_cached__dense_activation_gelu__decode_kernel
  .amdhsa_next_free_vgpr 160
  .amdhsa_next_free_sgpr 96
  .amdhsa_accum_offset 160
  .amdhsa_group_segment_fixed_size 0
  .amdhsa_kernarg_size 104
  .amdhsa_user_sgpr_count 2
  .amdhsa_user_sgpr_kernarg_segment_ptr 1
  .amdhsa_system_sgpr_workgroup_id_x 1
  .amdhsa_float_denorm_mode_32 3
.end_amdhsa_kernel
```
